```python
import torch

def _softmax(x, axis=-1):
    return torch.softmax(x, dim=axis)
def _gelu(x):
    return torch.nn.functional.gelu(x, approximate="tanh")
def _silu(x):
    return torch.nn.functional.silu(x)
def _sigmoid(x):
    return torch.sigmoid(x)
def _layernorm(x, axis=-1, eps=1e-5):
    m = x.mean(dim=axis, keepdim=True)
    v = x.var(dim=axis, keepdim=True, unbiased=False)
    return (x - m) / torch.sqrt(v + eps)
def _scatter_add(tgt, idx, src, axis=0):
    return tgt.clone().index_add_(axis, idx, src)
def _segment_sum(src, seg, n):
    out = torch.zeros((n,) + src.shape[1:], dtype=src.dtype)
    return out.index_add_(0, seg, src)
def _pad(x, pw):
    flat = tuple(v for pair in reversed(pw) for v in pair)
    return torch.nn.functional.pad(x, flat)

kernel_name = 'interleave_layers__sliding_block__ssm_conv_h3__prompt'

def setup_inputs():

    _w = (lambda a: (lambda t: t.to(torch.bfloat16) if t.is_floating_point() else t)(torch.as_tensor(a)))
    def _A_setup():
        B, S, D = 1, 2048, 640
        return {
            "x": _w((lambda *s: torch.randn(*s, dtype=torch.bfloat16) * 0.05)(B, S, D)),
            "wqkv": _w((lambda *s: torch.randn(*s, dtype=torch.bfloat16) * 0.05)(D, 3 * D)),
            "wo": _w((lambda *s: torch.randn(*s, dtype=torch.bfloat16) * 0.05)(D, D)),
        }
    _A_in = _A_setup()

    def _B_setup():
        B, S, D = 1, 2048, 640
        ks = 4
        return {
            "q": _w((lambda *s: torch.randn(*s, dtype=torch.bfloat16) * 0.05)(B, S, D)),
            "k": _w((lambda *s: torch.randn(*s, dtype=torch.bfloat16) * 0.4)(B, S, D)),
            "v": _w((lambda *s: torch.randn(*s, dtype=torch.bfloat16) * 0.4)(B, S, D)),
            "shift_k": _w((lambda *s: torch.randn(*s, dtype=torch.bfloat16) * 0.4)(D, ks) * 0.5),
            "ssm_k": _w((lambda *s: torch.randn(*s, dtype=torch.bfloat16) * 0.8)(D, S) * (1.0 / S ** 0.5)),
            "ssm_D": _w((lambda *s: torch.randn(*s, dtype=torch.bfloat16) * 0.4)(D)),
        }
    _B_in = _B_setup()

    return {
        "A_x": _A_in["x"],
        "A_wqkv": _A_in["wqkv"],
        "A_wo": _A_in["wo"],
        "B_q": _B_in["q"],
        "B_k": _B_in["k"],
        "B_v": _B_in["v"],
        "B_shift_k": _B_in["shift_k"],
        "B_ssm_k": _B_in["ssm_k"],
        "B_ssm_D": _B_in["ssm_D"],
    }

def reference(A_x, A_wqkv, A_wo, B_q, B_k, B_v, B_shift_k, B_ssm_k, B_ssm_D):
    def _A_ref(x, wqkv, wo):
        B, S, D = x.shape
        H = 32; Dh = D // H; W = 256
        qkv = (lambda x, *d: x.permute(*d))((x @ wqkv).reshape(B, S, 3, H, Dh), 2, 0, 3, 1, 4)
        q, k, v = qkv[0], qkv[1], qkv[2]
        scores = torch.einsum("bhqd,bhkd->bhqk", q, k) * (Dh ** -0.5)
        idx = torch.arange(S)
        mask = (idx[:, None] - idx[None, :] >= 0) & (idx[:, None] - idx[None, :] < W)
        scores = torch.where(mask[None, None], scores, -1e9)
        p = _softmax(scores, axis=-1)
        o = torch.einsum("bhqk,bhkd->bhqd", p, v)
        return (lambda x, *d: x.permute(*d))(o, 0, 2, 1, 3).reshape(B, S, D) @ wo

    def _B_ref(q, k, v, shift_k, ssm_k, ssm_D):
        B, S, D = q.shape
        ks = shift_k.shape[-1]
        k_pad = _pad(k, ((0, 0), (ks - 1, 0), (0, 0)))
        k_shift = torch.zeros_like(k)
        for t in range(ks):
            k_shift = k_shift + k_pad[:, t:t + S, :] * shift_k[:, ks - 1 - t][None, None, :]
        kv = k_shift * v
        L = 2 * S
        kv_pad = _pad(kv, ((0, 0), (0, S), (0, 0)))
        kf_pad = _pad(ssm_k, ((0, 0), (0, S)))
        kv_f = (lambda x, axes=(-2,-1): torch.fft.rfft2(x.float(), dim=axes))(kv_pad[:, None, :, :], axes=(1, 2))
        kf_f = (lambda x, axes=(-2,-1): torch.fft.rfft2(x.float(), dim=axes))(kf_pad[:, None, :], axes=(1, 2))
        kf_f = (lambda x, *d: x.permute(*d))(kf_f, 1, 2, 0)
        y_f = kv_f * kf_f[None, :, :, :]
        y = (lambda x, s, axes=(-2,-1): torch.fft.irfft2(x, s=s, dim=axes).to(torch.bfloat16))(y_f, (1, L), axes=(1, 2))[:, 0, :S, :]
        y = y + kv * ssm_D[None, None, :]
        return q * y

    x = A_x
    x = x + _A_ref(_layernorm(x, axis=-1), A_wqkv, A_wo)
    x = x + _B_ref(_layernorm(x, axis=-1), B_k, B_v, B_shift_k, B_ssm_k, B_ssm_D)
    x = x + _A_ref(_layernorm(x, axis=-1), A_wqkv, A_wo)
    x = x + _B_ref(_layernorm(x, axis=-1), B_k, B_v, B_shift_k, B_ssm_k, B_ssm_D)
    return x
```

```asm
; @launch grid=(256,1,1) block=(256,1,1) lds=163840
.amdgcn_target "amdgcn-amd-amdhsa--gfx950"
.text
.globl interleave_layers__sliding_block__ssm_conv_h3__prompt_kernel
.p2align 8
.type interleave_layers__sliding_block__ssm_conv_h3__prompt_kernel,@function
interleave_layers__sliding_block__ssm_conv_h3__prompt_kernel:
    s_cmp_ge_u32 s2, 256
    s_cbranch_scc1 L_end
    s_load_dwordx8 s[20:27], s[0:1], 0
    s_load_dwordx16 s[28:43], s[0:1], 32
    s_getpc_b64 s[52:53]
L_pc0:
    s_sub_u32 s52, s52, L_pc0-interleave_layers__sliding_block__ssm_conv_h3__prompt_kernel
    s_subb_u32 s53, s53, 0
    s_lshr_b32 s54, s2, 3
    s_mul_i32 s54, s54, 1536
    v_lshlrev_b32 v2, 6, v0
    v_add_u32 v2, s54, v2
    v_cmp_gt_u32 vcc, 24, v0
    v_min_u32 v3, L_code_end-interleave_layers__sliding_block__ssm_conv_h3__prompt_kernel-4, v2
    s_and_saveexec_b64 s[54:55], vcc
    s_cbranch_execz L_nocodepf
    global_load_dword v62, v3, s[52:53]
L_nocodepf:
    s_mov_b64 exec, -1
    v_and_b32 v1, 63, v0
    v_lshrrev_b32 v36, 6, v0
    s_nop 0
    v_readfirstlane_b32 s46, v36
    s_and_b32 s44, s2, 7
    s_lshr_b32 s45, s2, 3
    s_lshr_b32 s47, s45, 3
    s_and_b32 s48, s45, 7
    s_mul_i32 s51, s44, 1048576
    s_mov_b32 s49, 0
    s_mov_b32 s50, 0
    s_mov_b32 s64, 0
    s_mov_b32 s65, 1280
    s_mov_b32 s67, 0
    s_lshl_b32 s52, s47, 3
    s_lshl_b32 s97, 0xff, s52
    s_mov_b32 s96, 0x5f800000
    v_lshlrev_b32 v22, 4, v1
    s_getreg_b32 s68, hwreg(HW_REG_XCC_ID)
    v_lshrrev_b32 v36, 3, v1
    v_and_b32 v37, 7, v1
    v_lshrrev_b32 v38, 4, v1
    v_xor_b32 v37, v37, v38
    v_lshlrev_b32 v37, 4, v37
    v_mul_u32_u24 v36, 1280, v36
    v_add_u32 v23, v36, v37
    v_xor_b32 v24, 64, v23
    v_lshrrev_b32 v36, 2, v1
    v_mul_u32_u24 v36, 3840, v36
    v_and_b32 v37, 3, v1
    v_min_u32 v37, 2, v37
    v_lshl_add_u32 v25, v37, 4, v36
    s_lshl_b32 s52, s44, 3
    s_add_u32 s53, s52, s46
    s_mul_i32 s70, s53, 40960
    s_add_u32 s53, s52, 7
    s_sub_u32 s53, s53, s46
    s_mul_i32 s71, s53, 40960
    s_mul_i32 s52, s45, 40
    s_and_b32 s52, s52, 0xfffffff0
    s_mul_i32 s72, s46, 61440
    s_add_u32 s72, s72, s52
    v_min_u32 v60, 59, v1
    v_lshlrev_b32 v60, 7, v60
    s_mul_i32 s52, s45, 7680
    v_add_u32 v60, s52, v60
    v_min_u32 v61, 14, v1
    v_lshlrev_b32 v61, 7, v61
    s_mul_i32 s53, s46, 1920
    s_add_u32 s52, s52, s53
    v_add_u32 v61, s52, v61
    v_min_u32 v59, 19, v1
    v_lshlrev_b32 v59, 7, v59
    s_mul_i32 s52, s45, 10240
    s_mul_i32 s53, s46, 2560
    s_add_u32 s52, s52, s53
    s_mul_i32 s53, s44, 327680
    s_add_u32 s52, s52, s53
    v_add_u32 v59, s52, v59
    s_lshl_b32 s73, s46, 13
    s_lshl_b32 s74, s46, 10
    v_and_b32 v36, 31, v1
    v_lshrrev_b32 v37, 5, v1
    v_lshrrev_b32 v38, 1, v36
    v_and_b32 v38, 7, v38
    v_xor_b32 v38, v37, v38
    v_lshlrev_b32 v38, 4, v38
    v_lshl_add_u32 v38, v36, 7, v38
    v_add_u32 v38, s73, v38
    v_add_u32 v26, 61440, v38
    v_xor_b32 v27, 32, v26
    v_xor_b32 v28, 64, v26
    v_xor_b32 v29, 96, v26
    v_add_u32 v30, 0x10000, v26
    v_add_u32 v31, 0x10000, v27
    v_add_u32 v32, 0x10000, v28
    v_add_u32 v33, 0x10000, v29
    v_and_b32 v36, 3, v1
    v_bfe_u32 v37, v1, 2, 2
    v_bfe_u32 v38, v1, 4, 1
    v_lshrrev_b32 v39, 5, v1
    v_lshl_add_u32 v39, v39, 3, v37
    v_lshlrev_b32 v39, 6, v39
    s_and_b32 s52, s45, 1
    s_lshl_b32 s52, s52, 3
    v_add_u32 v39, s52, v39
    v_and_b32 v40, 1, v36
    v_lshrrev_b32 v41, 1, v36
    v_lshl_add_u32 v40, v40, 1, v41
    v_lshl_add_u32 v41, v40, 3, v39
    v_add_u32 v42, 1, v38
    v_lshl_add_u32 v35, v42, 12, v41
    v_cmp_eq_u32 vcc, 1, v36
    s_nop 1
    v_cndmask_b32 v42, 0, 2, vcc
    v_cmp_le_u32 vcc, 2, v36
    s_nop 1
    v_cndmask_b32 v42, v42, 1, vcc
    v_lshlrev_b32 v42, 12, v42
    v_add3_u32 v42, v42, v39, 32
    v_cmp_eq_u32 vcc, 1, v38
    s_nop 1
    v_cndmask_b32 v34, v41, v42, vcc
    v_mov_b32 v176, 0x3f803f80
    v_mov_b32 v177, 0x3f803f80
    v_mov_b32 v178, 0x3f803f80
    v_mov_b32 v179, 0x3f803f80
    s_lshl_b32 s62, s44, 14
    s_lshl_b32 s53, s47, 12
    s_add_u32 s62, s62, s53
    s_lshr_b32 s53, s46, 1
    s_lshl_b32 s53, s53, 11
    s_add_u32 s62, s62, s53
    s_and_b32 s53, s46, 1
    s_lshl_b32 s53, s53, 8
    s_add_u32 s62, s62, s53
    s_add_u32 s62, s62, 131072
    s_bfe_u32 s53, s48, 0x10001
    s_lshl_b32 s53, s53, 10
    s_add_u32 s3, s62, s53
    s_lshr_b32 s53, s48, 2
    s_lshl_b32 s53, s53, 9
    s_add_u32 s3, s3, s53
    s_and_b32 s53, s48, 1
    s_lshl_b32 s53, s53, 3
    s_add_u32 s3, s3, s53
    s_lshl_b32 s52, s47, 1
    s_lshr_b32 s53, s46, 1
    s_add_u32 s52, s52, s53
    s_mul_i32 s52, s52, 40
    s_mul_i32 s53, s48, 5
    s_add_u32 s52, s52, s53
    s_lshl_b32 s52, s52, 10
    s_and_b32 s53, s46, 1
    s_lshl_b32 s53, s53, 8
    s_add_u32 s52, s52, s53
    s_add_u32 s52, s52, s51
    s_add_u32 s63, s52, 4521984
    v_and_b32 v0, 31, v1
    v_lshlrev_b32 v0, 2, v0
    s_waitcnt lgkmcnt(0)
    s_mov_b32 s8, s20
    s_and_b32 s9, s21, 0xffff
    s_mov_b32 s10, 2621440
    s_mov_b32 s11, 0x20000
    s_mov_b32 s12, s22
    s_and_b32 s13, s23, 0xffff
    s_mov_b32 s14, 2457600
    s_mov_b32 s15, 0x20000
    s_mov_b32 s4, s42
    s_and_b32 s5, s43, 0xffff
    s_mov_b32 s6, 268435456
    s_mov_b32 s7, 0x20000
    s_cmp_eq_u32 s46, 3
    s_cbranch_scc0 L_p0_noflag
    v_mov_b32 v36, 0
    v_mov_b32 v37, 0
    s_lshl_b32 s52, s44, 8
    s_lshl_b32 s53, s45, 2
    s_add_u32 s52, s52, s53
    s_add_u32 s53, s52, 4096
    v_writelane_b32 v37, s53, 0
    s_add_u32 s53, s52, 8192
    v_writelane_b32 v37, s53, 1
    s_lshl_b32 s54, s44, 5
    s_add_u32 s54, s54, s45
    s_lshl_b32 s54, s54, 7
    s_add_u32 s53, s54, 16384
    v_writelane_b32 v37, s53, 2
    s_add_u32 s53, s54, 49152
    v_writelane_b32 v37, s53, 3
    v_mov_b32 v38, 0
    v_mov_b32 v39, 0
    v_mov_b32 v40, 0
    v_mov_b32 v41, 0
    s_mov_b64 exec, 0x3
    buffer_store_dword v36, v37, s[4:7], 0 offen sc1
    s_mov_b64 exec, 0xc
    buffer_store_dwordx4 v[38:41], v37, s[4:7], 0 offen sc1
    s_mov_b64 exec, 1
    buffer_store_dword v36, v36, s[4:7], s52 offen
    s_mov_b64 exec, -1
L_p0_noflag:
    s_mov_b32 s16, s28
    s_and_b32 s17, s29, 0xffff
    s_mov_b32 s18, 2621440
    s_mov_b32 s19, 0x20000
    s_mul_i32 s52, s46, 192
    v_add_u32 v36, s52, v1
    s_lshl_b32 s53, s45, 6
    s_mul_i32 s53, s53, 1280
    s_mul_i32 s54, s44, 160
    s_add_u32 s53, s53, s54
    s_sub_u32 s54, s53, 5120
    s_mul_i32 s55, s46, 3072
    v_mul_u32_u24 v37, 6554, v36
    v_lshrrev_b32 v37, 16, v37
    v_mul_u32_u24 v37, 1120, v37
    v_lshl_add_u32 v38, v36, 4, v37
    v_add_u32 v36, 64, v36
    v_mul_u32_u24 v37, 6554, v36
    v_lshrrev_b32 v37, 16, v37
    v_mul_u32_u24 v37, 1120, v37
    v_lshl_add_u32 v39, v36, 4, v37
    v_add_u32 v36, 64, v36
    v_mul_u32_u24 v37, 6554, v36
    v_lshrrev_b32 v37, 16, v37
    v_mul_u32_u24 v37, 1120, v37
    v_lshl_add_u32 v40, v36, 4, v37
    v_add_u32 v41, s54, v38
    s_add_u32 m0, s55, 126976
    s_nop 0
    buffer_load_dwordx4 v41, s[16:19], 0 offen lds
    v_add_u32 v41, s54, v39
    s_add_u32 m0, s55, 128000
    s_nop 0
    buffer_load_dwordx4 v41, s[16:19], 0 offen lds
    v_add_u32 v41, s54, v40
    s_add_u32 m0, s55, 129024
    s_nop 0
    buffer_load_dwordx4 v41, s[16:19], 0 offen lds
    s_mov_b32 s16, s30
    s_and_b32 s17, s31, 0xffff
    s_mov_b32 s18, 2621440
    s_mov_b32 s19, 0x20000
    s_add_u32 m0, s55, 139264
    s_nop 0
    buffer_load_dwordx4 v38, s[16:19], s53 offen lds
    s_add_u32 m0, s55, 140288
    s_nop 0
    buffer_load_dwordx4 v39, s[16:19], s53 offen lds
    s_add_u32 m0, s55, 141312
    s_nop 0
    buffer_load_dwordx4 v40, s[16:19], s53 offen lds
    s_mov_b32 s16, s32
    s_and_b32 s17, s33, 0xffff
    s_mov_b32 s18, 5120
    s_mov_b32 s19, 0x20000
    s_mul_i32 s52, s44, 640
    v_lshlrev_b32 v36, 3, v1
    buffer_load_dwordx2 v[186:187], v36, s[16:19], s52 offen
    v_and_b32 v36, 15, v1
    v_lshlrev_b32 v36, 3, v36
    buffer_load_dwordx2 v[188:189], v36, s[16:19], s52 offen offset:512
    s_add_u32 m0, s74, 0
    s_add_u32 s52, s72, 0
    buffer_load_dwordx4 v25, s[12:15], s52 offen lds
    s_add_u32 m0, s74, 4096
    s_add_u32 s52, s72, 1280
    buffer_load_dwordx4 v25, s[12:15], s52 offen lds
    s_add_u32 m0, s74, 8192
    s_add_u32 s52, s72, 2560
    buffer_load_dwordx4 v25, s[12:15], s52 offen lds
    s_add_u32 m0, s73, 61440
    s_add_u32 s52, s70, 0
    buffer_load_dwordx4 v23, s[8:11], s52 offen lds
    s_add_u32 m0, s73, 62464
    s_add_u32 s52, s70, 10240
    buffer_load_dwordx4 v24, s[8:11], s52 offen lds
    s_add_u32 m0, s73, 63488
    s_add_u32 s52, s70, 20480
    buffer_load_dwordx4 v23, s[8:11], s52 offen lds
    s_add_u32 m0, s73, 64512
    s_add_u32 s52, s70, 30720
    buffer_load_dwordx4 v24, s[8:11], s52 offen lds
    s_add_u32 m0, s73, 65536
    s_add_u32 s52, s71, 0
    buffer_load_dwordx4 v23, s[8:11], s52 offen lds
    s_add_u32 m0, s73, 66560
    s_add_u32 s52, s71, 10240
    buffer_load_dwordx4 v24, s[8:11], s52 offen lds
    s_add_u32 m0, s73, 67584
    s_add_u32 s52, s71, 20480
    buffer_load_dwordx4 v23, s[8:11], s52 offen lds
    s_add_u32 m0, s73, 68608
    s_add_u32 s52, s71, 30720
    buffer_load_dwordx4 v24, s[8:11], s52 offen lds
    v_min_u32 v36, 7, v1
    v_lshlrev_b32 v36, 6, v36
    s_lshl_b32 s52, s44, 14
    s_lshl_b32 s53, s45, 9
    s_add_u32 s52, s52, s53
    s_lshl_b32 s53, s46, 17
    s_add_u32 s52, s52, s53
    s_add_u32 s52, s52, 131072
    buffer_load_dword v62, v36, s[4:7], s52 offen
    s_cmp_lt_u32 s45, 16
    s_cselect_b32 s77, 3, 2
    s_mul_i32 s52, s45, 3
    s_lshl_b32 s53, s45, 1
    s_add_u32 s53, s53, 16
    s_cmp_lt_u32 s45, 16
    s_cselect_b32 s76, s52, s53
    s_add_u32 s76, s76, s46
    s_min_u32 s76, s76, 79
    s_mul_i32 s52, s44, 80
    s_add_u32 s84, s52, s76
    s_lshr_b32 s54, s84, 1
    s_lshl_b32 s54, s54, 2
    s_add_u32 s58, s36, s54
    s_addc_u32 s59, s37, 0
    s_load_dword s79, s[58:59], 0
    s_cmp_eq_u32 s46, 3
    s_cbranch_scc0 L_p0_noarr
    s_waitcnt vmcnt(20)
    s_and_b32 s52, s68, 7
    s_lshl_b32 s52, s52, 3
    s_lshl_b64 s[54:55], 1, s52
    v_mov_b32 v36, s54
    v_mov_b32 v37, s55
    s_and_b32 s52, s44, 3
    s_lshl_b32 s52, s52, 6
    s_lshr_b32 s53, s44, 2
    s_lshl_b32 s53, s53, 3
    s_add_u32 s52, s52, s53
    v_mov_b32 v38, s52
    s_mov_b32 s16, s40
    s_and_b32 s17, s41, 0xffff
    s_mov_b32 s18, 256
    s_mov_b32 s19, 0x20000
    s_mov_b64 exec, 1
    buffer_atomic_add_x2 v[36:37], v38, s[16:19], 0 offen
    s_mov_b64 exec, -1
L_p0_noarr:
    s_waitcnt lgkmcnt(0)
    s_and_b32 s52, s84, 1
    s_cmp_eq_u32 s52, 1
    s_cselect_b32 s52, 0, 16
    s_lshl_b32 s79, s79, s52
    s_and_b32 s79, s79, 0xffff0000
    s_waitcnt vmcnt(12)
    s_barrier
    v_bfe_u32 v50, v1, 2, 2
    s_lshl_b32 s52, s46, 4
    v_add_u32 v50, s52, v50
    v_mul_u32_u24 v50, 160, v50
    v_and_b32 v51, 3, v1
    v_lshl_add_u32 v50, v51, 3, v50
    v_add_u32 v50, 126976, v50
    v_lshrrev_b32 v51, 4, v1
    v_lshl_add_u32 v46, v51, 5, v50
    v_and_b32 v52, 1, v51
    v_mul_u32_u24 v52, 1280, v52
    s_add_u32 m0, s74, 12288
    s_add_u32 s98, s72, 245760
    buffer_load_dwordx4 v25, s[12:15], s98 offen lds
    v_add3_u32 v47, v50, v52, 64
    v_add_u32 v47, 64, v47
    ds_read_b64_tr_b16 v[96:97], v46 offset:0
    ds_read_b64_tr_b16 v[98:99], v46 offset:640
    ds_read_b64_tr_b16 v[100:101], v46 offset:1280
    ds_read_b64_tr_b16 v[114:115], v46 offset:12288
    ds_read_b64_tr_b16 v[116:117], v46 offset:12928
    ds_read_b64_tr_b16 v[102:103], v46 offset:1280
    ds_read_b64_tr_b16 v[104:105], v46 offset:1920
    ds_read_b64_tr_b16 v[106:107], v46 offset:2560
    ds_read_b64_tr_b16 v[118:119], v46 offset:13568
    ds_read_b64_tr_b16 v[120:121], v46 offset:14208
    ds_read_b64_tr_b16 v[108:109], v47 offset:0
    ds_read_b64_tr_b16 v[110:111], v47 offset:640
    ds_read_b64_tr_b16 v[112:113], v47 offset:1280
    ds_read_b64_tr_b16 v[122:123], v47 offset:12288
    ds_read_b64_tr_b16 v[124:125], v47 offset:12928
    v_and_b32 v50, 7, v1
    s_add_u32 m0, s74, 16384
    s_add_u32 s98, s72, 247040
    buffer_load_dwordx4 v25, s[12:15], s98 offen lds
    s_lshl_b32 s52, s46, 1
    v_xor_b32 v52, s52, v50
    v_lshlrev_b32 v52, 4, v52
    v_lshl_add_u32 v48, v1, 7, v52
    v_add_u32 v48, 151552, v48
    v_and_b32 v52, 1, v51
    v_add_u32 v52, s52, v52
    v_xor_b32 v52, v52, v50
    v_lshlrev_b32 v52, 4, v52
    v_and_b32 v50, 15, v1
    v_add_u32 v50, 64, v50
    v_lshl_add_u32 v49, v50, 7, v52
    v_add_u32 v49, 151552, v49
    v_lshlrev_b32 v148, 16, v186
    v_and_b32 v149, 0xffff0000, v186
    v_lshlrev_b32 v150, 16, v187
    v_and_b32 v151, 0xffff0000, v187
    s_waitcnt lgkmcnt(10)
    v_and_b32 v129, 0xffff0000, v96
    s_add_u32 m0, s74, 20480
    s_add_u32 s98, s72, 248320
    buffer_load_dwordx4 v25, s[12:15], s98 offen lds
    v_lshlrev_b32 v130, 16, v97
    v_and_b32 v131, 0xffff0000, v97
    v_lshlrev_b32 v132, 16, v98
    v_and_b32 v133, 0xffff0000, v98
    v_lshlrev_b32 v134, 16, v99
    v_and_b32 v135, 0xffff0000, v99
    v_lshlrev_b32 v136, 16, v100
    v_and_b32 v137, 0xffff0000, v100
    v_lshlrev_b32 v138, 16, v101
    v_and_b32 v139, 0xffff0000, v101
    v_lshlrev_b32 v140, 16, v114
    v_and_b32 v141, 0xffff0000, v114
    v_lshlrev_b32 v142, 16, v115
    v_and_b32 v143, 0xffff0000, v115
    v_lshlrev_b32 v144, 16, v116
    v_and_b32 v145, 0xffff0000, v116
    v_lshlrev_b32 v146, 16, v117
    v_and_b32 v147, 0xffff0000, v117
    v_mul_f32 v152, v151, v129
    s_add_u32 m0, s73, 94208
    s_add_u32 s98, s70, 128
    buffer_load_dwordx4 v23, s[8:11], s98 offen lds
    v_fmac_f32 v152, v150, v130
    v_fmac_f32 v152, v149, v131
    v_fmac_f32 v152, v148, v132
    v_mul_f32 v153, v151, v130
    v_fmac_f32 v153, v150, v131
    v_fmac_f32 v153, v149, v132
    v_fmac_f32 v153, v148, v133
    v_mul_f32 v154, v151, v131
    v_fmac_f32 v154, v150, v132
    v_fmac_f32 v154, v149, v133
    v_fmac_f32 v154, v148, v134
    v_mul_f32 v155, v151, v132
    v_fmac_f32 v155, v150, v133
    v_fmac_f32 v155, v149, v134
    v_fmac_f32 v155, v148, v135
    v_mul_f32 v156, v151, v133
    v_fmac_f32 v156, v150, v134
    v_fmac_f32 v156, v149, v135
    s_add_u32 m0, s73, 95232
    s_add_u32 s98, s70, 10368
    buffer_load_dwordx4 v24, s[8:11], s98 offen lds
    v_fmac_f32 v156, v148, v136
    v_mul_f32 v157, v151, v134
    v_fmac_f32 v157, v150, v135
    v_fmac_f32 v157, v149, v136
    v_fmac_f32 v157, v148, v137
    v_mul_f32 v158, v151, v135
    v_fmac_f32 v158, v150, v136
    v_fmac_f32 v158, v149, v137
    v_fmac_f32 v158, v148, v138
    v_mul_f32 v159, v151, v136
    v_fmac_f32 v159, v150, v137
    v_fmac_f32 v159, v149, v138
    v_fmac_f32 v159, v148, v139
    v_pk_mul_f32 v[152:153], v[152:153], v[140:141]
    v_pk_mul_f32 v[154:155], v[154:155], v[142:143]
    v_pk_mul_f32 v[156:157], v[156:157], v[144:145]
    v_pk_mul_f32 v[158:159], v[158:159], v[146:147]
    v_cvt_pk_bf16_f32 v96, v159, v158
    v_cvt_pk_bf16_f32 v97, v157, v156
    s_add_u32 m0, s73, 96256
    s_add_u32 s98, s70, 20608
    buffer_load_dwordx4 v23, s[8:11], s98 offen lds
    v_cvt_pk_bf16_f32 v98, v155, v154
    v_cvt_pk_bf16_f32 v99, v153, v152
    ds_write_b128 v48, v[96:99]
    s_waitcnt lgkmcnt(6)
    v_and_b32 v129, 0xffff0000, v102
    v_lshlrev_b32 v130, 16, v103
    v_and_b32 v131, 0xffff0000, v103
    v_lshlrev_b32 v132, 16, v104
    v_and_b32 v133, 0xffff0000, v104
    v_lshlrev_b32 v134, 16, v105
    v_and_b32 v135, 0xffff0000, v105
    v_lshlrev_b32 v136, 16, v106
    v_and_b32 v137, 0xffff0000, v106
    v_lshlrev_b32 v138, 16, v107
    v_and_b32 v139, 0xffff0000, v107
    v_lshlrev_b32 v140, 16, v118
    v_and_b32 v141, 0xffff0000, v118
    v_lshlrev_b32 v142, 16, v119
    s_add_u32 m0, s73, 97280
    s_add_u32 s98, s70, 30848
    buffer_load_dwordx4 v24, s[8:11], s98 offen lds
    v_and_b32 v143, 0xffff0000, v119
    v_lshlrev_b32 v144, 16, v120
    v_and_b32 v145, 0xffff0000, v120
    v_lshlrev_b32 v146, 16, v121
    v_and_b32 v147, 0xffff0000, v121
    v_mul_f32 v152, v151, v129
    v_fmac_f32 v152, v150, v130
    v_fmac_f32 v152, v149, v131
    v_fmac_f32 v152, v148, v132
    v_mul_f32 v153, v151, v130
    v_fmac_f32 v153, v150, v131
    v_fmac_f32 v153, v149, v132
    v_fmac_f32 v153, v148, v133
    v_mul_f32 v154, v151, v131
    v_fmac_f32 v154, v150, v132
    v_fmac_f32 v154, v149, v133
    v_fmac_f32 v154, v148, v134
    v_mul_f32 v155, v151, v132
    v_fmac_f32 v155, v150, v133
    s_add_u32 m0, s73, 98304
    s_add_u32 s98, s71, 128
    buffer_load_dwordx4 v23, s[8:11], s98 offen lds
    v_fmac_f32 v155, v149, v134
    v_fmac_f32 v155, v148, v135
    v_mul_f32 v156, v151, v133
    v_fmac_f32 v156, v150, v134
    v_fmac_f32 v156, v149, v135
    v_fmac_f32 v156, v148, v136
    v_mul_f32 v157, v151, v134
    v_fmac_f32 v157, v150, v135
    v_fmac_f32 v157, v149, v136
    v_fmac_f32 v157, v148, v137
    v_mul_f32 v158, v151, v135
    v_fmac_f32 v158, v150, v136
    v_fmac_f32 v158, v149, v137
    v_fmac_f32 v158, v148, v138
    v_mul_f32 v159, v151, v136
    v_fmac_f32 v159, v150, v137
    v_fmac_f32 v159, v149, v138
    v_fmac_f32 v159, v148, v139
    v_pk_mul_f32 v[152:153], v[152:153], v[140:141]
    s_add_u32 m0, s73, 99328
    s_add_u32 s98, s71, 10368
    buffer_load_dwordx4 v24, s[8:11], s98 offen lds
    v_pk_mul_f32 v[154:155], v[154:155], v[142:143]
    v_pk_mul_f32 v[156:157], v[156:157], v[144:145]
    v_pk_mul_f32 v[158:159], v[158:159], v[146:147]
    v_cvt_pk_bf16_f32 v102, v159, v158
    v_cvt_pk_bf16_f32 v103, v157, v156
    v_cvt_pk_bf16_f32 v104, v155, v154
    v_cvt_pk_bf16_f32 v105, v153, v152
    v_xor_b32 v48, 16, v48
    ds_write_b128 v48, v[102:105]
    v_lshlrev_b32 v148, 16, v188
    v_and_b32 v149, 0xffff0000, v188
    v_lshlrev_b32 v150, 16, v189
    v_and_b32 v151, 0xffff0000, v189
    s_waitcnt lgkmcnt(2)
    v_and_b32 v129, 0xffff0000, v108
    v_lshlrev_b32 v130, 16, v109
    v_and_b32 v131, 0xffff0000, v109
    v_lshlrev_b32 v132, 16, v110
    s_add_u32 m0, s73, 100352
    s_add_u32 s98, s71, 20608
    buffer_load_dwordx4 v23, s[8:11], s98 offen lds
    v_and_b32 v133, 0xffff0000, v110
    v_lshlrev_b32 v134, 16, v111
    v_and_b32 v135, 0xffff0000, v111
    v_lshlrev_b32 v136, 16, v112
    v_and_b32 v137, 0xffff0000, v112
    v_lshlrev_b32 v138, 16, v113
    v_and_b32 v139, 0xffff0000, v113
    v_lshlrev_b32 v140, 16, v122
    v_and_b32 v141, 0xffff0000, v122
    v_lshlrev_b32 v142, 16, v123
    v_and_b32 v143, 0xffff0000, v123
    v_lshlrev_b32 v144, 16, v124
    v_and_b32 v145, 0xffff0000, v124
    v_lshlrev_b32 v146, 16, v125
    v_and_b32 v147, 0xffff0000, v125
    v_mul_f32 v152, v151, v129
    v_fmac_f32 v152, v150, v130
    v_fmac_f32 v152, v149, v131
    v_fmac_f32 v152, v148, v132
    s_add_u32 m0, s73, 101376
    s_add_u32 s98, s71, 30848
    buffer_load_dwordx4 v24, s[8:11], s98 offen lds
    v_mul_f32 v153, v151, v130
    v_fmac_f32 v153, v150, v131
    v_fmac_f32 v153, v149, v132
    v_fmac_f32 v153, v148, v133
    v_mul_f32 v154, v151, v131
    v_fmac_f32 v154, v150, v132
    v_fmac_f32 v154, v149, v133
    v_fmac_f32 v154, v148, v134
    v_mul_f32 v155, v151, v132
    v_fmac_f32 v155, v150, v133
    v_fmac_f32 v155, v149, v134
    v_fmac_f32 v155, v148, v135
    v_mul_f32 v156, v151, v133
    v_fmac_f32 v156, v150, v134
    v_fmac_f32 v156, v149, v135
    v_fmac_f32 v156, v148, v136
    v_mul_f32 v157, v151, v134
    v_fmac_f32 v157, v150, v135
    s_add_u32 m0, s74, 24576
    s_add_u32 s98, s72, 491520
    buffer_load_dwordx4 v25, s[12:15], s98 offen lds
    v_fmac_f32 v157, v149, v136
    v_fmac_f32 v157, v148, v137
    v_mul_f32 v158, v151, v135
    v_fmac_f32 v158, v150, v136
    v_fmac_f32 v158, v149, v137
    v_fmac_f32 v158, v148, v138
    v_mul_f32 v159, v151, v136
    v_fmac_f32 v159, v150, v137
    v_fmac_f32 v159, v149, v138
    v_fmac_f32 v159, v148, v139
    v_pk_mul_f32 v[152:153], v[152:153], v[140:141]
    v_pk_mul_f32 v[154:155], v[154:155], v[142:143]
    v_pk_mul_f32 v[156:157], v[156:157], v[144:145]
    v_pk_mul_f32 v[158:159], v[158:159], v[146:147]
    v_cvt_pk_bf16_f32 v108, v159, v158
    v_cvt_pk_bf16_f32 v109, v157, v156
    v_cvt_pk_bf16_f32 v110, v155, v154
    v_cvt_pk_bf16_f32 v111, v153, v152
    s_mov_b32 exec_hi, 0
    ds_write_b128 v49, v[108:111]
    s_mov_b32 exec_hi, -1
    s_add_u32 m0, s74, 28672
    s_add_u32 s98, s72, 492800
    buffer_load_dwordx4 v25, s[12:15], s98 offen lds
    s_lshl_b32 s54, s45, 7
    s_add_u32 s54, s54, s51
    s_add_u32 s54, s54, 4521984
    v_lshrrev_b32 v46, 3, v1
    v_and_b32 v47, 7, v1
    v_xor_b32 v47, v47, v46
    v_lshlrev_b32 v47, 4, v47
    v_lshl_add_u32 v47, v46, 12, v47
    s_mul_i32 s52, s46, 3
    s_add_u32 s52, s52, 0
    s_min_u32 s52, s52, 9
    s_lshl_b32 s53, s52, 10
    s_add_u32 s53, s53, 151552
    v_add_u32 v48, s53, v22
    s_lshl_b32 s56, s52, 15
    s_add_u32 s56, s56, s54
    s_mul_i32 s52, s46, 3
    s_add_u32 m0, s74, 32768
    s_add_u32 s98, s72, 494080
    buffer_load_dwordx4 v25, s[12:15], s98 offen lds
    s_add_u32 s52, s52, 1
    s_min_u32 s52, s52, 9
    s_lshl_b32 s53, s52, 10
    s_add_u32 s53, s53, 151552
    v_add_u32 v49, s53, v22
    s_lshl_b32 s57, s52, 15
    s_add_u32 s57, s57, s54
    s_mul_i32 s52, s46, 3
    s_add_u32 s52, s52, 2
    s_min_u32 s52, s52, 9
    s_lshl_b32 s53, s52, 10
    s_add_u32 s53, s53, 151552
    v_add_u32 v50, s53, v22
    s_lshl_b32 s58, s52, 15
    s_add_u32 s58, s58, s54
    s_waitcnt lgkmcnt(0)
    s_barrier
    ds_read_b128 v[128:131], v48
    ds_read_b128 v[132:135], v49
    ds_read_b128 v[136:139], v50
    s_waitcnt lgkmcnt(2)
    buffer_store_dwordx4 v[128:131], v47, s[4:7], s56 offen
    s_waitcnt lgkmcnt(1)
    buffer_store_dwordx4 v[132:135], v47, s[4:7], s57 offen
    s_waitcnt lgkmcnt(0)
    buffer_store_dwordx4 v[136:139], v47, s[4:7], s58 offen
    s_waitcnt vmcnt(18)
    s_barrier
    s_mov_b32 s16, s40
    s_and_b32 s17, s41, 0xffff
    s_mov_b32 s18, 256
    s_mov_b32 s19, 0x20000
    v_and_b32 v36, 3, v1
    v_lshlrev_b32 v36, 6, v36
    v_bfe_u32 v37, v1, 2, 1
    v_lshl_add_u32 v36, v37, 3, v36
    buffer_load_dwordx2 v[44:45], v36, s[16:19], 0 offen sc1
    ds_read_b64_tr_b16 a[0:1], v34 offset:0
    ds_read_b64_tr_b16 a[2:3], v34 offset:256
    ds_read_b64_tr_b16 a[4:5], v35 offset:0
    ds_read_b64_tr_b16 a[6:7], v35 offset:256
    ds_read_b128 v[160:163], v26 offset:0
    ds_read_b128 v[164:167], v26 offset:4096
    s_lshl_b32 s53, s44, 8
    s_lshl_b32 s54, s47, 6
    s_add_u32 s53, s53, s54
    s_mul_i32 s53, s53, 1280
    s_mul_i32 s54, s48, 160
    s_add_u32 s53, s53, s54
    s_mul_i32 s55, s46, 3
    s_add_u32 s55, s55, 0
    s_min_u32 s55, s55, 9
    s_lshl_b32 s54, s55, 6
    v_add_u32 v36, s54, v1
    v_mul_u32_u24 v37, 6554, v36
    v_lshrrev_b32 v37, 16, v37
    v_mul_u32_u24 v37, 1120, v37
    v_lshl_add_u32 v38, v36, 4, v37
    s_lshl_b32 s55, s55, 10
    s_add_u32 m0, s55, 50688
    s_nop 0
    buffer_load_dwordx4 v38, s[8:11], s53 offen lds
    s_mul_i32 s55, s46, 3
    s_add_u32 s55, s55, 1
    s_min_u32 s55, s55, 9
    s_lshl_b32 s54, s55, 6
    v_add_u32 v36, s54, v1
    v_mul_u32_u24 v37, 6554, v36
    v_lshrrev_b32 v37, 16, v37
    v_mul_u32_u24 v37, 1120, v37
    v_lshl_add_u32 v38, v36, 4, v37
    s_lshl_b32 s55, s55, 10
    s_add_u32 m0, s55, 50688
    s_nop 0
    buffer_load_dwordx4 v38, s[8:11], s53 offen lds
    s_mul_i32 s55, s46, 3
    s_add_u32 s55, s55, 2
    s_min_u32 s55, s55, 9
    s_lshl_b32 s54, s55, 6
    v_add_u32 v36, s54, v1
    v_mul_u32_u24 v37, 6554, v36
    v_lshrrev_b32 v37, 16, v37
    v_mul_u32_u24 v37, 1120, v37
    v_lshl_add_u32 v38, v36, 4, v37
    s_lshl_b32 s55, s55, 10
    s_add_u32 m0, s55, 50688
    s_nop 0
    buffer_load_dwordx4 v38, s[8:11], s53 offen lds
    s_waitcnt lgkmcnt(0)
    v_mfma_f32_32x32x16_bf16 v[64:79], a[0:3], v[160:163], 0
    ds_read_b128 v[168:171], v27 offset:0
    ds_read_b128 v[172:175], v27 offset:4096
    s_add_u32 m0, s73, 126976
    s_add_u32 s52, s70, 256
    buffer_load_dwordx4 v23, s[8:11], s52 offen lds
    v_mfma_f32_32x32x16_bf16 v[80:95], a[4:7], v[160:163], 0
    ds_read_b64_tr_b16 a[8:9], v34 offset:1024
    ds_read_b64_tr_b16 a[10:11], v34 offset:1280
    v_mfma_f32_32x32x16_bf16 v[96:111], a[0:3], v[164:167], 0
    ds_read_b64_tr_b16 a[12:13], v35 offset:1024
    s_add_u32 m0, s73, 128000
    s_add_u32 s52, s70, 10496
    buffer_load_dwordx4 v24, s[8:11], s52 offen lds
    v_mfma_f32_32x32x16_bf16 v[112:127], a[4:7], v[164:167], 0
    ds_read_b64_tr_b16 a[14:15], v35 offset:1280
    s_add_u32 m0, s73, 129024
    s_add_u32 s52, s70, 20736
    buffer_load_dwordx4 v23, s[8:11], s52 offen lds
    v_mfma_f32_32x32x16_bf16 v[128:143], a[0:3], v[176:179], 0
    v_mfma_f32_32x32x16_bf16 v[144:159], a[4:7], v[176:179], 0
    s_add_u32 m0, s73, 130048
    s_add_u32 s52, s70, 30976
    buffer_load_dwordx4 v24, s[8:11], s52 offen lds
    s_waitcnt lgkmcnt(0)
    v_mfma_f32_32x32x16_bf16 v[64:79], a[8:11], v[168:171], v[64:79]
    ds_read_b128 v[160:163], v28 offset:0
    ds_read_b128 v[164:167], v28 offset:4096
    v_mfma_f32_32x32x16_bf16 v[80:95], a[12:15], v[168:171], v[80:95]
    ds_read_b64_tr_b16 a[16:17], v34 offset:2048
    ds_read_b64_tr_b16 a[18:19], v34 offset:2304
    s_add_u32 m0, s73, 131072
    s_add_u32 s52, s71, 256
    buffer_load_dwordx4 v23, s[8:11], s52 offen lds
    v_mfma_f32_32x32x16_bf16 v[96:111], a[8:11], v[172:175], v[96:111]
    ds_read_b64_tr_b16 a[20:21], v35 offset:2048
    v_mfma_f32_32x32x16_bf16 v[112:127], a[12:15], v[172:175], v[112:127]
    ds_read_b64_tr_b16 a[22:23], v35 offset:2304
    s_add_u32 m0, s73, 132096
    s_add_u32 s52, s71, 10496
    buffer_load_dwordx4 v24, s[8:11], s52 offen lds
    v_mfma_f32_32x32x16_bf16 v[128:143], a[8:11], v[176:179], v[128:143]
    s_add_u32 m0, s73, 133120
    s_add_u32 s52, s71, 20736
    buffer_load_dwordx4 v23, s[8:11], s52 offen lds
    v_mfma_f32_32x32x16_bf16 v[144:159], a[12:15], v[176:179], v[144:159]
    s_waitcnt vmcnt(17)
    s_barrier
    s_waitcnt lgkmcnt(0)
    v_mfma_f32_32x32x16_bf16 v[64:79], a[16:19], v[160:163], v[64:79]
    ds_read_b128 v[168:171], v29 offset:0
    ds_read_b128 v[172:175], v29 offset:4096
    s_add_u32 m0, s73, 134144
    s_add_u32 s52, s71, 30976
    buffer_load_dwordx4 v24, s[8:11], s52 offen lds
    v_mfma_f32_32x32x16_bf16 v[80:95], a[20:23], v[160:163], v[80:95]
    ds_read_b64_tr_b16 a[24:25], v34 offset:3072
    ds_read_b64_tr_b16 a[26:27], v34 offset:3328
    v_mfma_f32_32x32x16_bf16 v[96:111], a[16:19], v[164:167], v[96:111]
    ds_read_b64_tr_b16 a[28:29], v35 offset:3072
    s_add_u32 m0, s74, 36864
    s_add_u32 s52, s72, 737280
    buffer_load_dwordx4 v25, s[12:15], s52 offen lds
    v_mfma_f32_32x32x16_bf16 v[112:127], a[20:23], v[164:167], v[112:127]
    ds_read_b64_tr_b16 a[30:31], v35 offset:3328
    v_mfma_f32_32x32x16_bf16 v[128:143], a[16:19], v[176:179], v[128:143]
    v_mfma_f32_32x32x16_bf16 v[144:159], a[20:23], v[176:179], v[144:159]
    s_add_u32 m0, s74, 40960
    s_add_u32 s52, s72, 738560
    buffer_load_dwordx4 v25, s[12:15], s52 offen lds
    s_waitcnt lgkmcnt(0)
    v_mfma_f32_32x32x16_bf16 v[64:79], a[24:27], v[168:171], v[64:79]
    ds_read_b128 v[160:163], v26 offset:32768
    ds_read_b128 v[164:167], v26 offset:36864
    v_mfma_f32_32x32x16_bf16 v[80:95], a[28:31], v[168:171], v[80:95]
    ds_read_b64_tr_b16 a[32:33], v34 offset:12288
    ds_read_b64_tr_b16 a[34:35], v34 offset:12544
    v_mfma_f32_32x32x16_bf16 v[96:111], a[24:27], v[172:175], v[96:111]
    ds_read_b64_tr_b16 a[36:37], v35 offset:12288
    v_mfma_f32_32x32x16_bf16 v[112:127], a[28:31], v[172:175], v[112:127]
    ds_read_b64_tr_b16 a[38:39], v35 offset:12544
    s_add_u32 m0, s74, 45056
    s_add_u32 s52, s72, 739840
    buffer_load_dwordx4 v25, s[12:15], s52 offen lds
    v_mfma_f32_32x32x16_bf16 v[128:143], a[24:27], v[176:179], v[128:143]
    v_mfma_f32_32x32x16_bf16 v[144:159], a[28:31], v[176:179], v[144:159]
    s_waitcnt lgkmcnt(0)
    v_mfma_f32_32x32x16_bf16 v[64:79], a[32:35], v[160:163], v[64:79]
    ds_read_b128 v[168:171], v27 offset:32768
    ds_read_b128 v[172:175], v27 offset:36864
    s_add_u32 m0, s73, 61440
    s_add_u32 s52, s70, 384
    buffer_load_dwordx4 v23, s[8:11], s52 offen lds
    v_mfma_f32_32x32x16_bf16 v[80:95], a[36:39], v[160:163], v[80:95]
    ds_read_b64_tr_b16 a[40:41], v34 offset:13312
    ds_read_b64_tr_b16 a[42:43], v34 offset:13568
    v_mfma_f32_32x32x16_bf16 v[96:111], a[32:35], v[164:167], v[96:111]
    ds_read_b64_tr_b16 a[44:45], v35 offset:13312
    s_add_u32 m0, s73, 62464
    s_add_u32 s52, s70, 10624
    buffer_load_dwordx4 v24, s[8:11], s52 offen lds
    v_mfma_f32_32x32x16_bf16 v[112:127], a[36:39], v[164:167], v[112:127]
    ds_read_b64_tr_b16 a[46:47], v35 offset:13568
    s_add_u32 m0, s73, 63488
    s_add_u32 s52, s70, 20864
    buffer_load_dwordx4 v23, s[8:11], s52 offen lds
    v_mfma_f32_32x32x16_bf16 v[128:143], a[32:35], v[176:179], v[128:143]
    v_mfma_f32_32x32x16_bf16 v[144:159], a[36:39], v[176:179], v[144:159]
    s_add_u32 m0, s73, 64512
    s_add_u32 s52, s70, 31104
    buffer_load_dwordx4 v24, s[8:11], s52 offen lds
    s_waitcnt lgkmcnt(0)
    v_mfma_f32_32x32x16_bf16 v[64:79], a[40:43], v[168:171], v[64:79]
    ds_read_b128 v[160:163], v28 offset:32768
    ds_read_b128 v[164:167], v28 offset:36864
    v_mfma_f32_32x32x16_bf16 v[80:95], a[44:47], v[168:171], v[80:95]
    ds_read_b64_tr_b16 a[48:49], v34 offset:14336
    ds_read_b64_tr_b16 a[50:51], v34 offset:14592
    s_add_u32 m0, s73, 65536
    s_add_u32 s52, s71, 384
    buffer_load_dwordx4 v23, s[8:11], s52 offen lds
    v_mfma_f32_32x32x16_bf16 v[96:111], a[40:43], v[172:175], v[96:111]
    ds_read_b64_tr_b16 a[52:53], v35 offset:14336
    v_mfma_f32_32x32x16_bf16 v[112:127], a[44:47], v[172:175], v[112:127]
    ds_read_b64_tr_b16 a[54:55], v35 offset:14592
    s_add_u32 m0, s73, 66560
    s_add_u32 s52, s71, 10624
    buffer_load_dwordx4 v24, s[8:11], s52 offen lds
    v_mfma_f32_32x32x16_bf16 v[128:143], a[40:43], v[176:179], v[128:143]
    s_add_u32 m0, s73, 67584
    s_add_u32 s52, s71, 20864
    buffer_load_dwordx4 v23, s[8:11], s52 offen lds
    v_mfma_f32_32x32x16_bf16 v[144:159], a[44:47], v[176:179], v[144:159]
    s_waitcnt vmcnt(10)
    s_barrier
    s_waitcnt lgkmcnt(0)
    v_mfma_f32_32x32x16_bf16 v[64:79], a[48:51], v[160:163], v[64:79]
    ds_read_b128 v[168:171], v29 offset:32768
    ds_read_b128 v[172:175], v29 offset:36864
    s_add_u32 m0, s73, 68608
    s_add_u32 s52, s71, 31104
    buffer_load_dwordx4 v24, s[8:11], s52 offen lds
    v_mfma_f32_32x32x16_bf16 v[80:95], a[52:55], v[160:163], v[80:95]
    ds_read_b64_tr_b16 a[56:57], v34 offset:15360
    ds_read_b64_tr_b16 a[58:59], v34 offset:15616
    v_mfma_f32_32x32x16_bf16 v[96:111], a[48:51], v[164:167], v[96:111]
    ds_read_b64_tr_b16 a[60:61], v35 offset:15360
    s_add_u32 m0, s74, 0
    s_add_u32 s52, s72, 983040
    buffer_load_dwordx4 v25, s[12:15], s52 offen lds
    v_mfma_f32_32x32x16_bf16 v[112:127], a[52:55], v[164:167], v[112:127]
    ds_read_b64_tr_b16 a[62:63], v35 offset:15616
    v_mfma_f32_32x32x16_bf16 v[128:143], a[48:51], v[176:179], v[128:143]
    v_mfma_f32_32x32x16_bf16 v[144:159], a[52:55], v[176:179], v[144:159]
    s_add_u32 m0, s74, 4096
    s_add_u32 s52, s72, 984320
    buffer_load_dwordx4 v25, s[12:15], s52 offen lds
    s_waitcnt lgkmcnt(0)
    v_mfma_f32_32x32x16_bf16 v[64:79], a[56:59], v[168:171], v[64:79]
    ds_read_b128 v[160:163], v30 offset:0
    ds_read_b128 v[164:167], v30 offset:4096
    v_mfma_f32_32x32x16_bf16 v[80:95], a[60:63], v[168:171], v[80:95]
    ds_read_b64_tr_b16 a[64:65], v34 offset:24576
    ds_read_b64_tr_b16 a[66:67], v34 offset:24832
    v_mfma_f32_32x32x16_bf16 v[96:111], a[56:59], v[172:175], v[96:111]
    ds_read_b64_tr_b16 a[68:69], v35 offset:24576
    v_mfma_f32_32x32x16_bf16 v[112:127], a[60:63], v[172:175], v[112:127]
    ds_read_b64_tr_b16 a[70:71], v35 offset:24832
    s_add_u32 m0, s74, 8192
    s_add_u32 s52, s72, 985600
    buffer_load_dwordx4 v25, s[12:15], s52 offen lds
    v_mfma_f32_32x32x16_bf16 v[128:143], a[56:59], v[176:179], v[128:143]
    v_mfma_f32_32x32x16_bf16 v[144:159], a[60:63], v[176:179], v[144:159]
    s_waitcnt lgkmcnt(0)
    v_mfma_f32_32x32x16_bf16 v[64:79], a[64:67], v[160:163], v[64:79]
    ds_read_b128 v[168:171], v31 offset:0
    ds_read_b128 v[172:175], v31 offset:4096
    s_add_u32 m0, s73, 94208
    s_add_u32 s52, s70, 512
    buffer_load_dwordx4 v23, s[8:11], s52 offen lds
    v_and_b32 v36, 15, v1
    s_lshl_b32 s56, s46, 4
    v_add_u32 v36, s56, v36
    v_mul_u32_u24 v36, 160, v36
    v_mfma_f32_32x32x16_bf16 v[80:95], a[68:71], v[160:163], v[80:95]
    ds_read_b64_tr_b16 a[72:73], v34 offset:25600
    ds_read_b64_tr_b16 a[74:75], v34 offset:25856
    v_lshrrev_b32 v37, 4, v1
    v_lshl_add_u32 v36, v37, 3, v36
    v_add_u32 v36, 50688, v36
    ds_read_b64 v[2:3], v36 offset:0
    v_mfma_f32_32x32x16_bf16 v[96:111], a[64:67], v[164:167], v[96:111]
    ds_read_b64_tr_b16 a[76:77], v35 offset:25600
    s_add_u32 m0, s73, 95232
    s_add_u32 s52, s70, 10752
    buffer_load_dwordx4 v24, s[8:11], s52 offen lds
    ds_read_b64 v[4:5], v36 offset:32
    ds_read_b64 v[6:7], v36 offset:64
    ds_read_b64 v[8:9], v36 offset:96
    ds_read_b64 v[10:11], v36 offset:128
    v_mfma_f32_32x32x16_bf16 v[112:127], a[68:71], v[164:167], v[112:127]
    ds_read_b64_tr_b16 a[78:79], v35 offset:25856
    s_add_u32 m0, s73, 96256
    s_add_u32 s52, s70, 20992
    buffer_load_dwordx4 v23, s[8:11], s52 offen lds
    s_waitcnt lgkmcnt(1)
    v_lshlrev_b32 v180, 16, v2
    v_and_b32 v181, 0xffff0000, v2
    v_pk_mul_f32 v[184:185], v[180:181], v[180:181]
    v_mfma_f32_32x32x16_bf16 v[128:143], a[64:67], v[176:179], v[128:143]
    v_mov_b32 v182, v180
    v_mov_b32 v183, v181
    v_lshlrev_b32 v180, 16, v3
    v_and_b32 v181, 0xffff0000, v3
    v_mfma_f32_32x32x16_bf16 v[144:159], a[68:71], v[176:179], v[144:159]
    s_add_u32 m0, s73, 97280
    s_add_u32 s52, s70, 31232
    buffer_load_dwordx4 v24, s[8:11], s52 offen lds
    v_pk_add_f32 v[182:183], v[182:183], v[180:181]
    v_pk_fma_f32 v[184:185], v[180:181], v[180:181], v[184:185]
    v_lshlrev_b32 v180, 16, v4
    v_and_b32 v181, 0xffff0000, v4
    s_waitcnt lgkmcnt(0)
    v_mfma_f32_32x32x16_bf16 v[64:79], a[72:75], v[168:171], v[64:79]
    ds_read_b128 v[160:163], v32 offset:0
    ds_read_b128 v[164:167], v32 offset:4096
    v_pk_add_f32 v[182:183], v[182:183], v[180:181]
    v_pk_fma_f32 v[184:185], v[180:181], v[180:181], v[184:185]
    v_lshlrev_b32 v180, 16, v5
    v_and_b32 v181, 0xffff0000, v5
    v_mfma_f32_32x32x16_bf16 v[80:95], a[76:79], v[168:171], v[80:95]
    ds_read_b64_tr_b16 a[80:81], v34 offset:26624
    ds_read_b64_tr_b16 a[82:83], v34 offset:26880
    s_add_u32 m0, s73, 98304
    s_add_u32 s52, s71, 512
    buffer_load_dwordx4 v23, s[8:11], s52 offen lds
    v_pk_add_f32 v[182:183], v[182:183], v[180:181]
    v_pk_fma_f32 v[184:185], v[180:181], v[180:181], v[184:185]
    v_lshlrev_b32 v180, 16, v6
    v_and_b32 v181, 0xffff0000, v6
    v_mfma_f32_32x32x16_bf16 v[96:111], a[72:75], v[172:175], v[96:111]
    ds_read_b64_tr_b16 a[84:85], v35 offset:26624
    v_pk_add_f32 v[182:183], v[182:183], v[180:181]
    v_pk_fma_f32 v[184:185], v[180:181], v[180:181], v[184:185]
    v_lshlrev_b32 v180, 16, v7
    v_and_b32 v181, 0xffff0000, v7
    v_mfma_f32_32x32x16_bf16 v[112:127], a[76:79], v[172:175], v[112:127]
    ds_read_b64_tr_b16 a[86:87], v35 offset:26880
    s_add_u32 m0, s73, 99328
    s_add_u32 s52, s71, 10752
    buffer_load_dwordx4 v24, s[8:11], s52 offen lds
    v_pk_add_f32 v[182:183], v[182:183], v[180:181]
    v_pk_fma_f32 v[184:185], v[180:181], v[180:181], v[184:185]
    v_lshlrev_b32 v180, 16, v8
    v_and_b32 v181, 0xffff0000, v8
    v_mfma_f32_32x32x16_bf16 v[128:143], a[72:75], v[176:179], v[128:143]
    s_add_u32 m0, s73, 100352
    s_add_u32 s52, s71, 20992
    buffer_load_dwordx4 v23, s[8:11], s52 offen lds
    v_pk_add_f32 v[182:183], v[182:183], v[180:181]
    v_pk_fma_f32 v[184:185], v[180:181], v[180:181], v[184:185]
    v_lshlrev_b32 v180, 16, v9
    v_and_b32 v181, 0xffff0000, v9
    v_mfma_f32_32x32x16_bf16 v[144:159], a[76:79], v[176:179], v[144:159]
    v_pk_add_f32 v[182:183], v[182:183], v[180:181]
    v_pk_fma_f32 v[184:185], v[180:181], v[180:181], v[184:185]
    v_lshlrev_b32 v180, 16, v10
    v_and_b32 v181, 0xffff0000, v10
    s_waitcnt vmcnt(10)
    s_mov_b32 s54, 0x01010101
    s_lshl_b32 s55, 1, s44
    v_add_u32 v55, v44, v45
    v_mul_lo_u32 v55, v55, s54
    v_lshrrev_b32 v55, 24, v55
    v_cmp_le_u32 vcc, 32, v55
    s_nop 0
    s_and_b32 s52, vcc_lo, s55
    s_cmp_eq_u32 s52, s55
    s_cbranch_scc1 Lea_1_ok
    v_and_b32 v53, 3, v1
    v_lshlrev_b32 v53, 6, v53
    v_bfe_u32 v54, v1, 2, 1
    v_lshl_add_u32 v53, v54, 3, v53
    s_mov_b32 s66, 0x40000
Lea_1_spin:
    buffer_load_dwordx2 v[44:45], v53, s[16:19], 0 offen sc1
    s_waitcnt vmcnt(0)
    v_add_u32 v55, v44, v45
    v_mul_lo_u32 v55, v55, s54
    v_lshrrev_b32 v55, 24, v55
    v_cmp_le_u32 vcc, 32, v55
    s_nop 0
    s_and_b32 s52, vcc_lo, s55
    s_cmp_eq_u32 s52, s55
    s_cbranch_scc1 Lea_1_ok
    s_sub_u32 s66, s66, 1
    s_cmp_lg_u32 s66, 0
    s_cbranch_scc1 Lea_1_spin
Lea_1_ok:
    v_readlane_b32 s52, v44, s44
    v_readlane_b32 s53, v45, s44
    s_bcnt1_i32_b32 s52, s52
    s_bcnt1_i32_b32 s53, s53
    s_add_u32 s52, s52, s53
    s_cmp_eq_u32 s52, 1
    s_cselect_b32 s50, 1, 0
    s_lshl_b32 s52, s44, 8
    s_cmp_eq_u32 s50, 1
    s_cselect_b32 s64, 0, 4096
    s_add_u32 s64, s64, s52
    s_lshl_b32 s52, s45, 2
    s_add_u32 s67, s64, s52
    s_barrier
    s_waitcnt lgkmcnt(0)
    v_mfma_f32_32x32x16_bf16 v[64:79], a[80:83], v[160:163], v[64:79]
    ds_read_b128 v[168:171], v33 offset:0
    ds_read_b128 v[172:175], v33 offset:4096
    s_add_u32 m0, s73, 101376
    s_add_u32 s52, s71, 31232
    buffer_load_dwordx4 v24, s[8:11], s52 offen lds
    v_pk_add_f32 v[182:183], v[182:183], v[180:181]
    v_pk_fma_f32 v[184:185], v[180:181], v[180:181], v[184:185]
    v_lshlrev_b32 v180, 16, v11
    v_and_b32 v181, 0xffff0000, v11
    v_mfma_f32_32x32x16_bf16 v[80:95], a[84:87], v[160:163], v[80:95]
    ds_read_b64_tr_b16 a[88:89], v34 offset:27648
    ds_read_b64_tr_b16 a[90:91], v34 offset:27904
    v_pk_add_f32 v[182:183], v[182:183], v[180:181]
    v_pk_fma_f32 v[184:185], v[180:181], v[180:181], v[184:185]
    v_add_f32 v38, v182, v183
    v_add_f32 v39, v184, v185
    v_mfma_f32_32x32x16_bf16 v[96:111], a[80:83], v[164:167], v[96:111]
    ds_read_b64_tr_b16 a[92:93], v35 offset:27648
    s_add_u32 m0, s74, 12288
    s_add_u32 s52, s72, 1228800
    buffer_load_dwordx4 v25, s[12:15], s52 offen lds
    v_mov_b32 v180, v38
    v_mov_b32 v181, v39
    s_nop 0
    v_permlane16_swap_b32 v180, v38
    v_permlane16_swap_b32 v181, v39
    v_mfma_f32_32x32x16_bf16 v[112:127], a[84:87], v[164:167], v[112:127]
    ds_read_b64_tr_b16 a[94:95], v35 offset:27904
    v_add_f32 v38, v38, v180
    v_add_f32 v39, v39, v181
    v_mov_b32 v180, v38
    v_mov_b32 v181, v39
    v_mfma_f32_32x32x16_bf16 v[128:143], a[80:83], v[176:179], v[128:143]
    v_permlane32_swap_b32 v180, v38
    v_permlane32_swap_b32 v181, v39
    v_add_f32 v38, v38, v180
    v_add_f32 v39, v39, v181
    v_mfma_f32_32x32x16_bf16 v[144:159], a[84:87], v[176:179], v[144:159]
    s_add_u32 m0, s74, 16384
    s_add_u32 s52, s72, 1230080
    buffer_load_dwordx4 v25, s[12:15], s52 offen lds
    s_waitcnt lgkmcnt(0)
    v_mfma_f32_32x32x16_bf16 v[64:79], a[88:91], v[168:171], v[64:79]
    ds_read_b128 v[160:163], v26 offset:0
    ds_read_b128 v[164:167], v26 offset:4096
    v_mfma_f32_32x32x16_bf16 v[80:95], a[92:95], v[168:171], v[80:95]
    ds_read_b64_tr_b16 a[96:97], v34 offset:36864
    ds_read_b64_tr_b16 a[98:99], v34 offset:37120
    v_mfma_f32_32x32x16_bf16 v[96:111], a[88:91], v[172:175], v[96:111]
    ds_read_b64_tr_b16 a[100:101], v35 offset:36864
    v_mfma_f32_32x32x16_bf16 v[112:127], a[92:95], v[172:175], v[112:127]
    ds_read_b64_tr_b16 a[102:103], v35 offset:37120
    s_add_u32 m0, s74, 20480
    s_add_u32 s52, s72, 1231360
    buffer_load_dwordx4 v25, s[12:15], s52 offen lds
    v_mfma_f32_32x32x16_bf16 v[128:143], a[88:91], v[176:179], v[128:143]
    v_mfma_f32_32x32x16_bf16 v[144:159], a[92:95], v[176:179], v[144:159]
    s_add_u32 s52, s3, 0
    s_mov_b64 exec, 0xffff
    buffer_store_dwordx2 v[38:39], v22, s[4:7], s52 offen
    s_mov_b64 exec, -1
    v_mov_b32 v38, -1
    v_mov_b32 v39, -1
    s_add_u32 s52, s3, 131072
    s_mov_b64 exec, 0xffff
    buffer_store_dwordx2 v[38:39], v22, s[4:7], s52 offen
    s_mov_b64 exec, -1
    s_add_u32 s52, s3, 393216
    s_mov_b64 exec, 0xffff
    buffer_store_dwordx2 v[38:39], v22, s[4:7], s52 offen
    s_mov_b64 exec, -1
    s_waitcnt lgkmcnt(0)
    v_mfma_f32_32x32x16_bf16 v[64:79], a[96:99], v[160:163], v[64:79]
    ds_read_b128 v[168:171], v27 offset:0
    ds_read_b128 v[172:175], v27 offset:4096
    s_add_u32 m0, s73, 126976
    s_add_u32 s52, s70, 640
    buffer_load_dwordx4 v23, s[8:11], s52 offen lds
    v_mfma_f32_32x32x16_bf16 v[80:95], a[100:103], v[160:163], v[80:95]
    ds_read_b64_tr_b16 a[104:105], v34 offset:37888
    ds_read_b64_tr_b16 a[106:107], v34 offset:38144
    v_mfma_f32_32x32x16_bf16 v[96:111], a[96:99], v[164:167], v[96:111]
    ds_read_b64_tr_b16 a[108:109], v35 offset:37888
    s_add_u32 m0, s73, 128000
    s_add_u32 s52, s70, 10880
    buffer_load_dwordx4 v24, s[8:11], s52 offen lds
    v_mfma_f32_32x32x16_bf16 v[112:127], a[100:103], v[164:167], v[112:127]
    ds_read_b64_tr_b16 a[110:111], v35 offset:38144
    s_add_u32 m0, s73, 129024
    s_add_u32 s52, s70, 21120
    buffer_load_dwordx4 v23, s[8:11], s52 offen lds
    v_mfma_f32_32x32x16_bf16 v[128:143], a[96:99], v[176:179], v[128:143]
    v_mfma_f32_32x32x16_bf16 v[144:159], a[100:103], v[176:179], v[144:159]
    s_add_u32 m0, s73, 130048
    s_add_u32 s52, s70, 31360
    buffer_load_dwordx4 v24, s[8:11], s52 offen lds
    s_waitcnt lgkmcnt(0)
    v_mfma_f32_32x32x16_bf16 v[64:79], a[104:107], v[168:171], v[64:79]
    ds_read_b128 v[160:163], v28 offset:0
    ds_read_b128 v[164:167], v28 offset:4096
    v_mfma_f32_32x32x16_bf16 v[80:95], a[108:111], v[168:171], v[80:95]
    ds_read_b64_tr_b16 a[112:113], v34 offset:38912
    ds_read_b64_tr_b16 a[114:115], v34 offset:39168
    s_add_u32 m0, s73, 131072
    s_add_u32 s52, s71, 640
    buffer_load_dwordx4 v23, s[8:11], s52 offen lds
    v_mfma_f32_32x32x16_bf16 v[96:111], a[104:107], v[172:175], v[96:111]
    ds_read_b64_tr_b16 a[116:117], v35 offset:38912
    v_mfma_f32_32x32x16_bf16 v[112:127], a[108:111], v[172:175], v[112:127]
    ds_read_b64_tr_b16 a[118:119], v35 offset:39168
    s_add_u32 m0, s73, 132096
    s_add_u32 s52, s71, 10880
    buffer_load_dwordx4 v24, s[8:11], s52 offen lds
    v_mfma_f32_32x32x16_bf16 v[128:143], a[104:107], v[176:179], v[128:143]
    s_add_u32 m0, s73, 133120
    s_add_u32 s52, s71, 21120
    buffer_load_dwordx4 v23, s[8:11], s52 offen lds
    v_mfma_f32_32x32x16_bf16 v[144:159], a[108:111], v[176:179], v[144:159]
    s_waitcnt vmcnt(13)
    s_barrier
    s_waitcnt lgkmcnt(0)
    v_mfma_f32_32x32x16_bf16 v[64:79], a[112:115], v[160:163], v[64:79]
    ds_read_b128 v[168:171], v29 offset:0
    ds_read_b128 v[172:175], v29 offset:4096
    s_add_u32 m0, s73, 134144
    s_add_u32 s52, s71, 31360
    buffer_load_dwordx4 v24, s[8:11], s52 offen lds
    v_mfma_f32_32x32x16_bf16 v[80:95], a[116:119], v[160:163], v[80:95]
    ds_read_b64_tr_b16 a[120:121], v34 offset:39936
    ds_read_b64_tr_b16 a[122:123], v34 offset:40192
    v_mfma_f32_32x32x16_bf16 v[96:111], a[112:115], v[164:167], v[96:111]
    ds_read_b64_tr_b16 a[124:125], v35 offset:39936
    s_add_u32 m0, s74, 24576
    s_add_u32 s52, s72, 1474560
    buffer_load_dwordx4 v25, s[12:15], s52 offen lds
    v_mfma_f32_32x32x16_bf16 v[112:127], a[116:119], v[164:167], v[112:127]
    ds_read_b64_tr_b16 a[126:127], v35 offset:40192
    v_mfma_f32_32x32x16_bf16 v[128:143], a[112:115], v[176:179], v[128:143]
    v_mfma_f32_32x32x16_bf16 v[144:159], a[116:119], v[176:179], v[144:159]
    s_add_u32 m0, s74, 28672
    s_add_u32 s52, s72, 1475840
    buffer_load_dwordx4 v25, s[12:15], s52 offen lds
    s_waitcnt lgkmcnt(0)
    v_mfma_f32_32x32x16_bf16 v[64:79], a[120:123], v[168:171], v[64:79]
    ds_read_b128 v[160:163], v26 offset:32768
    ds_read_b128 v[164:167], v26 offset:36864
    v_mfma_f32_32x32x16_bf16 v[80:95], a[124:127], v[168:171], v[80:95]
    ds_read_b64_tr_b16 a[128:129], v34 offset:0
    ds_read_b64_tr_b16 a[130:131], v34 offset:256
    v_mfma_f32_32x32x16_bf16 v[96:111], a[120:123], v[172:175], v[96:111]
    ds_read_b64_tr_b16 a[132:133], v35 offset:0
    v_mfma_f32_32x32x16_bf16 v[112:127], a[124:127], v[172:175], v[112:127]
    ds_read_b64_tr_b16 a[134:135], v35 offset:256
    s_add_u32 m0, s74, 32768
    s_add_u32 s52, s72, 1477120
    buffer_load_dwordx4 v25, s[12:15], s52 offen lds
    v_mfma_f32_32x32x16_bf16 v[128:143], a[120:123], v[176:179], v[128:143]
    v_mfma_f32_32x32x16_bf16 v[144:159], a[124:127], v[176:179], v[144:159]
    s_waitcnt lgkmcnt(0)
    v_mfma_f32_32x32x16_bf16 v[64:79], a[128:131], v[160:163], v[64:79]
    ds_read_b128 v[168:171], v27 offset:32768
    ds_read_b128 v[172:175], v27 offset:36864
    s_add_u32 m0, s73, 61440
    s_add_u32 s52, s70, 768
    buffer_load_dwordx4 v23, s[8:11], s52 offen lds
    v_mfma_f32_32x32x16_bf16 v[80:95], a[132:135], v[160:163], v[80:95]
    ds_read_b64_tr_b16 a[136:137], v34 offset:1024
    ds_read_b64_tr_b16 a[138:139], v34 offset:1280
    v_mfma_f32_32x32x16_bf16 v[96:111], a[128:131], v[164:167], v[96:111]
    ds_read_b64_tr_b16 a[140:141], v35 offset:1024
    s_add_u32 m0, s73, 62464
    s_add_u32 s52, s70, 11008
    buffer_load_dwordx4 v24, s[8:11], s52 offen lds
    v_mfma_f32_32x32x16_bf16 v[112:127], a[132:135], v[164:167], v[112:127]
    ds_read_b64_tr_b16 a[142:143], v35 offset:1280
    s_add_u32 m0, s73, 63488
    s_add_u32 s52, s70, 21248
    buffer_load_dwordx4 v23, s[8:11], s52 offen lds
    v_mfma_f32_32x32x16_bf16 v[128:143], a[128:131], v[176:179], v[128:143]
    v_mfma_f32_32x32x16_bf16 v[144:159], a[132:135], v[176:179], v[144:159]
    s_add_u32 m0, s73, 64512
    s_add_u32 s52, s70, 31488
    buffer_load_dwordx4 v24, s[8:11], s52 offen lds
    s_waitcnt lgkmcnt(0)
    v_mfma_f32_32x32x16_bf16 v[64:79], a[136:139], v[168:171], v[64:79]
    ds_read_b128 v[160:163], v28 offset:32768
    ds_read_b128 v[164:167], v28 offset:36864
    v_mfma_f32_32x32x16_bf16 v[80:95], a[140:143], v[168:171], v[80:95]
    ds_read_b64_tr_b16 a[144:145], v34 offset:2048
    ds_read_b64_tr_b16 a[146:147], v34 offset:2304
    s_add_u32 m0, s73, 65536
    s_add_u32 s52, s71, 768
    buffer_load_dwordx4 v23, s[8:11], s52 offen lds
    v_mfma_f32_32x32x16_bf16 v[96:111], a[136:139], v[172:175], v[96:111]
    ds_read_b64_tr_b16 a[148:149], v35 offset:2048
    v_mfma_f32_32x32x16_bf16 v[112:127], a[140:143], v[172:175], v[112:127]
    ds_read_b64_tr_b16 a[150:151], v35 offset:2304
    s_add_u32 m0, s73, 66560
    s_add_u32 s52, s71, 11008
    buffer_load_dwordx4 v24, s[8:11], s52 offen lds
    v_mfma_f32_32x32x16_bf16 v[128:143], a[136:139], v[176:179], v[128:143]
    s_add_u32 m0, s73, 67584
    s_add_u32 s52, s71, 21248
    buffer_load_dwordx4 v23, s[8:11], s52 offen lds
    v_mfma_f32_32x32x16_bf16 v[144:159], a[140:143], v[176:179], v[144:159]
    s_waitcnt vmcnt(10)
    s_barrier
    s_cmp_eq_u32 s46, 3
    s_cbranch_scc0 L_p1_nosig
    v_mov_b32 v36, 2
    s_mov_b64 exec, 1
    s_cmp_eq_u32 s50, 1
    s_cbranch_scc0 Lsig_2_slow
    buffer_store_dword v36, v22, s[4:7], s67 offen
Lsig_2_done:
    s_mov_b64 exec, -1
L_p1_nosig:
    s_waitcnt lgkmcnt(0)
    v_mfma_f32_32x32x16_bf16 v[64:79], a[144:147], v[160:163], v[64:79]
    ds_read_b128 v[168:171], v29 offset:32768
    ds_read_b128 v[172:175], v29 offset:36864
    s_add_u32 m0, s73, 68608
    s_add_u32 s52, s71, 31488
    buffer_load_dwordx4 v24, s[8:11], s52 offen lds
    v_mfma_f32_32x32x16_bf16 v[80:95], a[148:151], v[160:163], v[80:95]
    ds_read_b64_tr_b16 a[152:153], v34 offset:3072
    ds_read_b64_tr_b16 a[154:155], v34 offset:3328
    v_mfma_f32_32x32x16_bf16 v[96:111], a[144:147], v[164:167], v[96:111]
    ds_read_b64_tr_b16 a[156:157], v35 offset:3072
    s_add_u32 m0, s74, 36864
    s_add_u32 s52, s72, 1720320
    buffer_load_dwordx4 v25, s[12:15], s52 offen lds
    v_mfma_f32_32x32x16_bf16 v[112:127], a[148:151], v[164:167], v[112:127]
    ds_read_b64_tr_b16 a[158:159], v35 offset:3328
    v_mfma_f32_32x32x16_bf16 v[128:143], a[144:147], v[176:179], v[128:143]
    v_mfma_f32_32x32x16_bf16 v[144:159], a[148:151], v[176:179], v[144:159]
    s_add_u32 m0, s74, 40960
    s_add_u32 s52, s72, 1721600
    buffer_load_dwordx4 v25, s[12:15], s52 offen lds
    s_waitcnt lgkmcnt(0)
    v_mfma_f32_32x32x16_bf16 v[64:79], a[152:155], v[168:171], v[64:79]
    ds_read_b128 v[160:163], v30 offset:0
    ds_read_b128 v[164:167], v30 offset:4096
    v_mfma_f32_32x32x16_bf16 v[80:95], a[156:159], v[168:171], v[80:95]
    ds_read_b64_tr_b16 a[160:161], v34 offset:12288
    ds_read_b64_tr_b16 a[162:163], v34 offset:12544
    v_mfma_f32_32x32x16_bf16 v[96:111], a[152:155], v[172:175], v[96:111]
    ds_read_b64_tr_b16 a[164:165], v35 offset:12288
    v_mfma_f32_32x32x16_bf16 v[112:127], a[156:159], v[172:175], v[112:127]
    ds_read_b64_tr_b16 a[166:167], v35 offset:12544
    s_add_u32 m0, s74, 45056
    s_add_u32 s52, s72, 1722880
    buffer_load_dwordx4 v25, s[12:15], s52 offen lds
    v_mfma_f32_32x32x16_bf16 v[128:143], a[152:155], v[176:179], v[128:143]
    v_mfma_f32_32x32x16_bf16 v[144:159], a[156:159], v[176:179], v[144:159]
    s_waitcnt lgkmcnt(0)
    v_mfma_f32_32x32x16_bf16 v[64:79], a[160:163], v[160:163], v[64:79]
    ds_read_b128 v[168:171], v31 offset:0
    ds_read_b128 v[172:175], v31 offset:4096
    s_add_u32 m0, s73, 94208
    s_add_u32 s52, s70, 896
    buffer_load_dwordx4 v23, s[8:11], s52 offen lds
    v_and_b32 v36, 31, v1
    v_lshrrev_b32 v37, 5, v1
    v_mfma_f32_32x32x16_bf16 v[80:95], a[164:167], v[160:163], v[80:95]
    ds_read_b64_tr_b16 a[168:169], v34 offset:13312
    ds_read_b64_tr_b16 a[170:171], v34 offset:13568
    v_lshlrev_b32 v37, 2, v37
    v_sub_u32 v36, v36, v37
    v_mfma_f32_32x32x16_bf16 v[96:111], a[160:163], v[164:167], v[96:111]
    ds_read_b64_tr_b16 a[172:173], v35 offset:13312
    s_add_u32 m0, s73, 95232
    s_add_u32 s52, s70, 11136
    buffer_load_dwordx4 v24, s[8:11], s52 offen lds
    s_lshl_b32 s56, s46, 3
    v_subrev_u32 v36, s56, v36
    v_mfma_f32_32x32x16_bf16 v[112:127], a[164:167], v[164:167], v[112:127]
    ds_read_b64_tr_b16 a[174:175], v35 offset:13568
    s_add_u32 m0, s73, 96256
    s_add_u32 s52, s70, 21376
    buffer_load_dwordx4 v23, s[8:11], s52 offen lds
    v_mov_b32 v37, 0xf149f2ca
    s_lshl_b32 s56, s46, 10
    v_mfma_f32_32x32x16_bf16 v[128:143], a[160:163], v[176:179], v[128:143]
    s_add_u32 s56, s56, 50688
    v_add_u32 v38, s56, v22
    v_mfma_f32_32x32x16_bf16 v[144:159], a[164:167], v[176:179], v[144:159]
    s_add_u32 m0, s73, 97280
    s_add_u32 s52, s70, 31616
    buffer_load_dwordx4 v24, s[8:11], s52 offen lds
    v_subrev_u32 v48, 0, v36
    v_subrev_u32 v49, 1, v36
    s_waitcnt lgkmcnt(0)
    v_mfma_f32_32x32x16_bf16 v[64:79], a[168:171], v[168:171], v[64:79]
    ds_read_b128 v[160:163], v32 offset:0
    ds_read_b128 v[164:167], v32 offset:4096
    v_subrev_u32 v50, 2, v36
    v_subrev_u32 v51, 3, v36
    v_mfma_f32_32x32x16_bf16 v[80:95], a[172:175], v[168:171], v[80:95]
    ds_read_b64_tr_b16 a[176:177], v34 offset:14336
    ds_read_b64_tr_b16 a[178:179], v34 offset:14592
    s_add_u32 m0, s73, 98304
    s_add_u32 s52, s71, 896
    buffer_load_dwordx4 v23, s[8:11], s52 offen lds
    v_ashrrev_i32 v48, 31, v48
    v_ashrrev_i32 v49, 31, v49
    v_mfma_f32_32x32x16_bf16 v[96:111], a[168:171], v[172:175], v[96:111]
    ds_read_b64_tr_b16 a[180:181], v35 offset:14336
    v_ashrrev_i32 v50, 31, v50
    v_ashrrev_i32 v51, 31, v51
    v_mfma_f32_32x32x16_bf16 v[112:127], a[172:175], v[172:175], v[112:127]
    ds_read_b64_tr_b16 a[182:183], v35 offset:14592
    s_add_u32 m0, s73, 99328
    s_add_u32 s52, s71, 11136
    buffer_load_dwordx4 v24, s[8:11], s52 offen lds
    v_and_b32 v48, v37, v48
    v_and_b32 v49, v37, v49
    v_mfma_f32_32x32x16_bf16 v[128:143], a[168:171], v[176:179], v[128:143]
    s_add_u32 m0, s73, 100352
    s_add_u32 s52, s71, 21376
    buffer_load_dwordx4 v23, s[8:11], s52 offen lds
    v_and_b32 v50, v37, v50
    v_and_b32 v51, v37, v51
    v_mfma_f32_32x32x16_bf16 v[144:159], a[172:175], v[176:179], v[144:159]
    ds_write_b128 v38, v[48:51]
    v_xor_b32 v52, v37, v48
    s_waitcnt vmcnt(10)
    s_barrier
    s_waitcnt lgkmcnt(1)
    v_mfma_f32_32x32x16_bf16 v[64:79], a[176:179], v[160:163], v[64:79]
    ds_read_b128 v[168:171], v33 offset:0
    ds_read_b128 v[172:175], v33 offset:4096
    s_add_u32 m0, s73, 101376
    s_add_u32 s52, s71, 31616
    buffer_load_dwordx4 v24, s[8:11], s52 offen lds
    v_xor_b32 v53, v37, v49
    v_xor_b32 v54, v37, v50
    v_mfma_f32_32x32x16_bf16 v[80:95], a[180:183], v[160:163], v[80:95]
    ds_read_b64_tr_b16 a[184:185], v34 offset:15360
    ds_read_b64_tr_b16 a[186:187], v34 offset:15616
    v_xor_b32 v55, v37, v51
    ds_write_b128 v38, v[52:55] offset:4096
    v_mfma_f32_32x32x16_bf16 v[96:111], a[176:179], v[164:167], v[96:111]
    ds_read_b64_tr_b16 a[188:189], v35 offset:15360
    s_add_u32 m0, s74, 0
    s_add_u32 s52, s72, 1966080
    buffer_load_dwordx4 v25, s[12:15], s52 offen lds
    v_mov_b32 v36, 0
    v_lshlrev_b32 v37, 2, v1
    v_mfma_f32_32x32x16_bf16 v[112:127], a[180:183], v[164:167], v[112:127]
    ds_read_b64_tr_b16 a[190:191], v35 offset:15616
    ds_write_b32 v37, v36 offset:49408
    v_mfma_f32_32x32x16_bf16 v[128:143], a[176:179], v[176:179], v[128:143]
    v_mfma_f32_32x32x16_bf16 v[144:159], a[180:183], v[176:179], v[144:159]
    s_add_u32 m0, s74, 4096
    s_add_u32 s52, s72, 1967360
    buffer_load_dwordx4 v25, s[12:15], s52 offen lds
    s_waitcnt lgkmcnt(1)
    v_mfma_f32_32x32x16_bf16 v[64:79], a[184:187], v[168:171], v[64:79]
    ds_read_b128 v[160:163], v26 offset:0
    ds_read_b128 v[164:167], v26 offset:4096
    v_mfma_f32_32x32x16_bf16 v[80:95], a[188:191], v[168:171], v[80:95]
    ds_read_b64_tr_b16 a[192:193], v34 offset:24576
    ds_read_b64_tr_b16 a[194:195], v34 offset:24832
    v_mfma_f32_32x32x16_bf16 v[96:111], a[184:187], v[172:175], v[96:111]
    ds_read_b64_tr_b16 a[196:197], v35 offset:24576
    v_mfma_f32_32x32x16_bf16 v[112:127], a[188:191], v[172:175], v[112:127]
    ds_read_b64_tr_b16 a[198:199], v35 offset:24832
    s_add_u32 m0, s74, 8192
    s_add_u32 s52, s72, 1968640
    buffer_load_dwordx4 v25, s[12:15], s52 offen lds
    v_mfma_f32_32x32x16_bf16 v[128:143], a[184:187], v[176:179], v[128:143]
    v_mfma_f32_32x32x16_bf16 v[144:159], a[188:191], v[176:179], v[144:159]
    s_waitcnt lgkmcnt(0)
    v_mfma_f32_32x32x16_bf16 v[64:79], a[192:195], v[160:163], v[64:79]
    ds_read_b128 v[168:171], v27 offset:0
    ds_read_b128 v[172:175], v27 offset:4096
    s_add_u32 m0, s73, 126976
    s_add_u32 s52, s70, 1024
    buffer_load_dwordx4 v23, s[8:11], s52 offen lds
    v_mfma_f32_32x32x16_bf16 v[80:95], a[196:199], v[160:163], v[80:95]
    ds_read_b64_tr_b16 a[200:201], v34 offset:25600
    ds_read_b64_tr_b16 a[202:203], v34 offset:25856
    v_mfma_f32_32x32x16_bf16 v[96:111], a[192:195], v[164:167], v[96:111]
    ds_read_b64_tr_b16 a[204:205], v35 offset:25600
    s_add_u32 m0, s73, 128000
    s_add_u32 s52, s70, 11264
    buffer_load_dwordx4 v24, s[8:11], s52 offen lds
    v_mfma_f32_32x32x16_bf16 v[112:127], a[196:199], v[164:167], v[112:127]
    ds_read_b64_tr_b16 a[206:207], v35 offset:25856
    s_add_u32 m0, s73, 129024
    s_add_u32 s52, s70, 21504
    buffer_load_dwordx4 v23, s[8:11], s52 offen lds
    v_mfma_f32_32x32x16_bf16 v[128:143], a[192:195], v[176:179], v[128:143]
    v_mfma_f32_32x32x16_bf16 v[144:159], a[196:199], v[176:179], v[144:159]
    s_add_u32 m0, s73, 130048
    s_add_u32 s52, s70, 31744
    buffer_load_dwordx4 v24, s[8:11], s52 offen lds
    s_waitcnt lgkmcnt(0)
    v_mfma_f32_32x32x16_bf16 v[64:79], a[200:203], v[168:171], v[64:79]
    ds_read_b128 v[160:163], v28 offset:0
    ds_read_b128 v[164:167], v28 offset:4096
    v_mfma_f32_32x32x16_bf16 v[80:95], a[204:207], v[168:171], v[80:95]
    ds_read_b64_tr_b16 a[208:209], v34 offset:26624
    ds_read_b64_tr_b16 a[210:211], v34 offset:26880
    s_add_u32 m0, s73, 131072
    s_add_u32 s52, s71, 1024
    buffer_load_dwordx4 v23, s[8:11], s52 offen lds
    v_mfma_f32_32x32x16_bf16 v[96:111], a[200:203], v[172:175], v[96:111]
    ds_read_b64_tr_b16 a[212:213], v35 offset:26624
    v_mfma_f32_32x32x16_bf16 v[112:127], a[204:207], v[172:175], v[112:127]
    ds_read_b64_tr_b16 a[214:215], v35 offset:26880
    s_add_u32 m0, s73, 132096
    s_add_u32 s52, s71, 11264
    buffer_load_dwordx4 v24, s[8:11], s52 offen lds
    v_mfma_f32_32x32x16_bf16 v[128:143], a[200:203], v[176:179], v[128:143]
    s_add_u32 m0, s73, 133120
    s_add_u32 s52, s71, 21504
    buffer_load_dwordx4 v23, s[8:11], s52 offen lds
    v_mfma_f32_32x32x16_bf16 v[144:159], a[204:207], v[176:179], v[144:159]
    s_waitcnt vmcnt(10)
    s_barrier
    v_and_b32 v36, 3, v1
    v_lshlrev_b32 v36, 6, v36
    v_bfe_u32 v37, v1, 2, 1
    v_lshl_add_u32 v36, v37, 3, v36
    buffer_load_dwordx2 v[44:45], v36, s[16:19], 0 offen sc1
    s_waitcnt lgkmcnt(0)
    v_mfma_f32_32x32x16_bf16 v[64:79], a[208:211], v[160:163], v[64:79]
    ds_read_b128 v[168:171], v29 offset:0
    ds_read_b128 v[172:175], v29 offset:4096
    s_add_u32 m0, s73, 134144
    s_add_u32 s52, s71, 31744
    buffer_load_dwordx4 v24, s[8:11], s52 offen lds
    v_mfma_f32_32x32x16_bf16 v[80:95], a[212:215], v[160:163], v[80:95]
    ds_read_b64_tr_b16 a[216:217], v34 offset:27648
    ds_read_b64_tr_b16 a[218:219], v34 offset:27904
    v_mfma_f32_32x32x16_bf16 v[96:111], a[208:211], v[164:167], v[96:111]
    ds_read_b64_tr_b16 a[220:221], v35 offset:27648
    s_add_u32 m0, s74, 12288
    s_add_u32 s52, s72, 2211840
    buffer_load_dwordx4 v25, s[12:15], s52 offen lds
    v_mfma_f32_32x32x16_bf16 v[112:127], a[212:215], v[164:167], v[112:127]
    ds_read_b64_tr_b16 a[222:223], v35 offset:27904
    v_mfma_f32_32x32x16_bf16 v[128:143], a[208:211], v[176:179], v[128:143]
    v_mfma_f32_32x32x16_bf16 v[144:159], a[212:215], v[176:179], v[144:159]
    s_add_u32 m0, s74, 16384
    s_add_u32 s52, s72, 2213120
    buffer_load_dwordx4 v25, s[12:15], s52 offen lds
    s_waitcnt lgkmcnt(0)
    v_mfma_f32_32x32x16_bf16 v[64:79], a[216:219], v[168:171], v[64:79]
    ds_read_b128 v[160:163], v26 offset:32768
    ds_read_b128 v[164:167], v26 offset:36864
    v_mfma_f32_32x32x16_bf16 v[80:95], a[220:223], v[168:171], v[80:95]
    ds_read_b64_tr_b16 a[224:225], v34 offset:36864
    ds_read_b64_tr_b16 a[226:227], v34 offset:37120
    v_mfma_f32_32x32x16_bf16 v[96:111], a[216:219], v[172:175], v[96:111]
    ds_read_b64_tr_b16 a[228:229], v35 offset:36864
    v_mfma_f32_32x32x16_bf16 v[112:127], a[220:223], v[172:175], v[112:127]
    ds_read_b64_tr_b16 a[230:231], v35 offset:37120
    s_add_u32 m0, s74, 20480
    s_add_u32 s52, s72, 2214400
    buffer_load_dwordx4 v25, s[12:15], s52 offen lds
    v_mfma_f32_32x32x16_bf16 v[128:143], a[216:219], v[176:179], v[128:143]
    v_mfma_f32_32x32x16_bf16 v[144:159], a[220:223], v[176:179], v[144:159]
    s_waitcnt lgkmcnt(0)
    v_mfma_f32_32x32x16_bf16 v[64:79], a[224:227], v[160:163], v[64:79]
    ds_read_b128 v[168:171], v27 offset:32768
    ds_read_b128 v[172:175], v27 offset:36864
    s_add_u32 m0, s73, 61440
    s_add_u32 s52, s70, 1152
    buffer_load_dwordx4 v23, s[8:11], s52 offen lds
    s_mov_b32 s12, s24
    s_and_b32 s13, s25, 0xffff
    v_mfma_f32_32x32x16_bf16 v[80:95], a[228:231], v[160:163], v[80:95]
    ds_read_b64_tr_b16 a[232:233], v34 offset:37888
    ds_read_b64_tr_b16 a[234:235], v34 offset:38144
    s_mov_b32 s14, 819200
    s_mov_b32 s15, 0x20000
    v_mfma_f32_32x32x16_bf16 v[96:111], a[224:227], v[164:167], v[96:111]
    ds_read_b64_tr_b16 a[236:237], v35 offset:37888
    s_add_u32 m0, s73, 62464
    s_add_u32 s52, s70, 11392
    buffer_load_dwordx4 v24, s[8:11], s52 offen lds
    v_mov_b32 v189, v1
    v_mul_u32_u24 v190, 6554, v189
    v_mfma_f32_32x32x16_bf16 v[112:127], a[228:231], v[164:167], v[112:127]
    ds_read_b64_tr_b16 a[238:239], v35 offset:38144
    s_add_u32 m0, s73, 63488
    s_add_u32 s52, s70, 21632
    buffer_load_dwordx4 v23, s[8:11], s52 offen lds
    v_lshrrev_b32 v190, 16, v190
    v_mul_u32_u24 v190, 1120, v190
    v_mfma_f32_32x32x16_bf16 v[128:143], a[224:227], v[176:179], v[128:143]
    v_lshl_add_u32 v184, v189, 4, v190
    v_add_u32 v189, 64, v189
    v_mfma_f32_32x32x16_bf16 v[144:159], a[228:231], v[176:179], v[144:159]
    s_add_u32 m0, s73, 64512
    s_add_u32 s52, s70, 31872
    buffer_load_dwordx4 v24, s[8:11], s52 offen lds
    v_mul_u32_u24 v190, 6554, v189
    v_lshrrev_b32 v190, 16, v190
    s_waitcnt lgkmcnt(0)
    v_mfma_f32_32x32x16_bf16 v[64:79], a[232:235], v[168:171], v[64:79]
    ds_read_b128 v[160:163], v28 offset:32768
    ds_read_b128 v[164:167], v28 offset:36864
    v_mul_u32_u24 v190, 1120, v190
    v_lshl_add_u32 v185, v189, 4, v190
    v_mfma_f32_32x32x16_bf16 v[80:95], a[236:239], v[168:171], v[80:95]
    ds_read_b64_tr_b16 a[240:241], v34 offset:38912
    ds_read_b64_tr_b16 a[242:243], v34 offset:39168
    s_add_u32 m0, s73, 65536
    s_add_u32 s52, s71, 1152
    buffer_load_dwordx4 v23, s[8:11], s52 offen lds
    v_add_u32 v189, 64, v189
    v_mul_u32_u24 v190, 6554, v189
    v_mfma_f32_32x32x16_bf16 v[96:111], a[232:235], v[172:175], v[96:111]
    ds_read_b64_tr_b16 a[244:245], v35 offset:38912
    v_lshrrev_b32 v190, 16, v190
    v_mul_u32_u24 v190, 1120, v190
    v_mfma_f32_32x32x16_bf16 v[112:127], a[236:239], v[172:175], v[112:127]
    ds_read_b64_tr_b16 a[246:247], v35 offset:39168
    s_add_u32 m0, s73, 66560
    s_add_u32 s52, s71, 11392
    buffer_load_dwordx4 v24, s[8:11], s52 offen lds
    v_lshl_add_u32 v186, v189, 4, v190
    v_add_u32 v189, 64, v189
    v_mfma_f32_32x32x16_bf16 v[128:143], a[232:235], v[176:179], v[128:143]
    s_add_u32 m0, s73, 67584
    s_add_u32 s52, s71, 21632
    buffer_load_dwordx4 v23, s[8:11], s52 offen lds
    v_mul_u32_u24 v190, 6554, v189
    v_lshrrev_b32 v190, 16, v190
    v_mfma_f32_32x32x16_bf16 v[144:159], a[236:239], v[176:179], v[144:159]
    v_mul_u32_u24 v190, 1120, v190
    v_lshl_add_u32 v187, v189, 4, v190
    s_waitcnt vmcnt(10)
    s_barrier
    buffer_load_dword v46, v0, s[4:7], s64 offen sc1
    s_waitcnt lgkmcnt(0)
    v_mfma_f32_32x32x16_bf16 v[64:79], a[240:243], v[160:163], v[64:79]
    ds_read_b128 v[168:171], v29 offset:32768
    ds_read_b128 v[172:175], v29 offset:36864
    s_add_u32 m0, s73, 68608
    s_add_u32 s52, s71, 31872
    buffer_load_dwordx4 v24, s[8:11], s52 offen lds
    v_add_u32 v189, 64, v189
    v_mul_u32_u24 v190, 6554, v189
    v_mfma_f32_32x32x16_bf16 v[80:95], a[244:247], v[160:163], v[80:95]
    ds_read_b64_tr_b16 a[248:249], v34 offset:39936
    ds_read_b64_tr_b16 a[250:251], v34 offset:40192
    v_lshrrev_b32 v190, 16, v190
    v_mul_u32_u24 v190, 1120, v190
    v_mfma_f32_32x32x16_bf16 v[96:111], a[240:243], v[164:167], v[96:111]
    ds_read_b64_tr_b16 a[252:253], v35 offset:39936
    v_lshl_add_u32 v188, v189, 4, v190
    s_mul_i32 s60, s48, 160
    v_mfma_f32_32x32x16_bf16 v[112:127], a[244:247], v[164:167], v[112:127]
    ds_read_b64_tr_b16 a[254:255], v35 offset:40192
    s_mul_i32 s61, s46, 81920
    s_add_u32 s60, s60, s61
    v_mfma_f32_32x32x16_bf16 v[128:143], a[240:243], v[176:179], v[128:143]
    s_mul_i32 s61, s46, 10240
    v_mfma_f32_32x32x16_bf16 v[144:159], a[244:247], v[176:179], v[144:159]
    s_waitcnt lgkmcnt(0)
    v_mfma_f32_32x32x16_bf16 v[64:79], a[248:251], v[168:171], v[64:79]
    ds_read_b128 v[160:163], v30 offset:0
    ds_read_b128 v[164:167], v30 offset:4096
    v_mfma_f32_32x32x16_bf16 v[80:95], a[252:255], v[168:171], v[80:95]
    ds_read_b64_tr_b16 v[192:193], v34 offset:0
    ds_read_b64_tr_b16 v[194:195], v34 offset:256
    v_mfma_f32_32x32x16_bf16 v[96:111], a[248:251], v[172:175], v[96:111]
    ds_read_b64_tr_b16 v[196:197], v35 offset:0
    v_mfma_f32_32x32x16_bf16 v[112:127], a[252:255], v[172:175], v[112:127]
    ds_read_b64_tr_b16 v[198:199], v35 offset:256
    v_mfma_f32_32x32x16_bf16 v[128:143], a[248:251], v[176:179], v[128:143]
    v_mfma_f32_32x32x16_bf16 v[144:159], a[252:255], v[176:179], v[144:159]
    s_waitcnt lgkmcnt(0)
    v_mfma_f32_32x32x16_bf16 v[64:79], v[192:195], v[160:163], v[64:79]
    ds_read_b128 v[168:171], v31 offset:0
    ds_read_b128 v[172:175], v31 offset:4096
    v_mfma_f32_32x32x16_bf16 v[80:95], v[196:199], v[160:163], v[80:95]
    ds_read_b64_tr_b16 v[200:201], v34 offset:1024
    ds_read_b64_tr_b16 v[202:203], v34 offset:1280
    v_mfma_f32_32x32x16_bf16 v[96:111], v[192:195], v[164:167], v[96:111]
    ds_read_b64_tr_b16 v[204:205], v35 offset:1024
    v_mfma_f32_32x32x16_bf16 v[112:127], v[196:199], v[164:167], v[112:127]
    ds_read_b64_tr_b16 v[206:207], v35 offset:1280
    v_mfma_f32_32x32x16_bf16 v[128:143], v[192:195], v[176:179], v[128:143]
    v_mfma_f32_32x32x16_bf16 v[144:159], v[196:199], v[176:179], v[144:159]
    s_waitcnt lgkmcnt(0)
    v_mfma_f32_32x32x16_bf16 v[64:79], v[200:203], v[168:171], v[64:79]
    ds_read_b128 v[160:163], v32 offset:0
    ds_read_b128 v[164:167], v32 offset:4096
    v_mfma_f32_32x32x16_bf16 v[80:95], v[204:207], v[168:171], v[80:95]
    ds_read_b64_tr_b16 v[208:209], v34 offset:2048
    ds_read_b64_tr_b16 v[210:211], v34 offset:2304
    v_mfma_f32_32x32x16_bf16 v[96:111], v[200:203], v[172:175], v[96:111]
    ds_read_b64_tr_b16 v[212:213], v35 offset:2048
    v_mfma_f32_32x32x16_bf16 v[112:127], v[204:207], v[172:175], v[112:127]
    ds_read_b64_tr_b16 v[214:215], v35 offset:2304
    v_mfma_f32_32x32x16_bf16 v[128:143], v[200:203], v[176:179], v[128:143]
    v_mfma_f32_32x32x16_bf16 v[144:159], v[204:207], v[176:179], v[144:159]
    s_waitcnt vmcnt(0)
    s_mov_b32 s54, 0x01010101
    s_mov_b32 s55, 0xff
    v_add_u32 v55, v44, v45
    v_mul_lo_u32 v55, v55, s54
    v_lshrrev_b32 v55, 24, v55
    v_cmp_le_u32 vcc, 32, v55
    s_nop 0
    s_and_b32 s52, vcc_lo, s55
    s_cmp_eq_u32 s52, s55
    s_cbranch_scc1 Lea_3_ok
    v_and_b32 v53, 3, v1
    v_lshlrev_b32 v53, 6, v53
    v_bfe_u32 v54, v1, 2, 1
    v_lshl_add_u32 v53, v54, 3, v53
    s_mov_b32 s66, 0x40000
Lea_3_spin:
    buffer_load_dwordx2 v[44:45], v53, s[16:19], 0 offen sc1
    s_waitcnt vmcnt(0)
    v_add_u32 v55, v44, v45
    v_mul_lo_u32 v55, v55, s54
    v_lshrrev_b32 v55, 24, v55
    v_cmp_le_u32 vcc, 32, v55
    s_nop 0
    s_and_b32 s52, vcc_lo, s55
    s_cmp_eq_u32 s52, s55
    s_cbranch_scc1 Lea_3_ok
    s_sub_u32 s66, s66, 1
    s_cmp_lg_u32 s66, 0
    s_cbranch_scc1 Lea_3_spin
Lea_3_ok:
    v_cmp_le_u32 vcc, 2, v46
    s_nop 0
    s_cmp_eq_u32 vcc_lo, -1
    s_cbranch_scc1 Lef_4_ok
    s_mov_b32 s66, 0x40000
Lwl_5:
    buffer_load_dword v36, v0, s[4:7], s64 offen sc1
    s_waitcnt vmcnt(0)
    v_cmp_le_u32 vcc, 2, v36
    s_nop 0
    s_cmp_eq_u32 vcc_lo, -1
    s_cbranch_scc0 Lwl_5_retry
Lwl_5_ok:
    s_cmp_eq_u32 s50, 1
    s_cbranch_scc0 Lwl_5_inv
Lwl_5_fin:
Lef_4_ok:
    s_cmp_eq_u32 s50, 1
    s_cbranch_scc1 Lef_4_fin
    buffer_inv sc1
    s_waitcnt vmcnt(0)
Lef_4_fin:
    s_barrier
    s_lshl_b32 s52, s44, 14
    s_add_u32 s52, s52, 131072
    s_lshl_b32 s53, s46, 11
    s_add_u32 s54, s52, s53
    s_add_u32 s52, s52, 14336
    s_sub_u32 s55, s52, s53
    buffer_load_dwordx4 v[44:47], v22, s[4:7], s54 offen sc1
    buffer_load_dwordx4 v[48:51], v22, s[4:7], s54 offen offset:1024 sc1
    buffer_load_dwordx4 v[52:55], v22, s[4:7], s55 offen sc1
    buffer_load_dwordx4 v[56:59], v22, s[4:7], s55 offen offset:1024 sc1
    s_waitcnt lgkmcnt(0)
    v_mfma_f32_32x32x16_bf16 v[64:79], v[208:211], v[160:163], v[64:79]
    ds_read_b128 v[168:171], v33 offset:0
    ds_read_b128 v[172:175], v33 offset:4096
    v_mfma_f32_32x32x16_bf16 v[80:95], v[212:215], v[160:163], v[80:95]
    ds_read_b64_tr_b16 v[216:217], v34 offset:3072
    ds_read_b64_tr_b16 v[218:219], v34 offset:3328
    v_mfma_f32_32x32x16_bf16 v[96:111], v[208:211], v[164:167], v[96:111]
    ds_read_b64_tr_b16 v[220:221], v35 offset:3072
    v_mfma_f32_32x32x16_bf16 v[112:127], v[212:215], v[164:167], v[112:127]
    ds_read_b64_tr_b16 v[222:223], v35 offset:3328
    v_mfma_f32_32x32x16_bf16 v[128:143], v[208:211], v[176:179], v[128:143]
    v_mfma_f32_32x32x16_bf16 v[144:159], v[212:215], v[176:179], v[144:159]
    s_waitcnt lgkmcnt(0)
    v_mfma_f32_32x32x16_bf16 v[64:79], v[216:219], v[168:171], v[64:79]
    ds_read_b128 v[160:163], v26 offset:0
    ds_read_b128 v[164:167], v26 offset:4096
    v_mfma_f32_32x32x16_bf16 v[80:95], v[220:223], v[168:171], v[80:95]
    ds_read_b64_tr_b16 v[224:225], v34 offset:12288
    ds_read_b64_tr_b16 v[226:227], v34 offset:12544
    v_mfma_f32_32x32x16_bf16 v[96:111], v[216:219], v[172:175], v[96:111]
    ds_read_b64_tr_b16 v[228:229], v35 offset:12288
    v_mfma_f32_32x32x16_bf16 v[112:127], v[220:223], v[172:175], v[112:127]
    ds_read_b64_tr_b16 v[230:231], v35 offset:12544
    v_mfma_f32_32x32x16_bf16 v[128:143], v[216:219], v[176:179], v[128:143]
    v_mfma_f32_32x32x16_bf16 v[144:159], v[220:223], v[176:179], v[144:159]
    s_barrier
    s_waitcnt lgkmcnt(0)
    v_mfma_f32_32x32x16_bf16 v[64:79], v[224:227], v[160:163], v[64:79]
    ds_read_b128 v[168:171], v27 offset:0
    ds_read_b128 v[172:175], v27 offset:4096
    s_lshl_b32 s53, s84, 12
    s_mov_b32 s16, s34
    s_and_b32 s17, s35, 0xffff
    v_mfma_f32_32x32x16_bf16 v[80:95], v[228:231], v[160:163], v[80:95]
    ds_read_b64_tr_b16 v[232:233], v34 offset:13312
    ds_read_b64_tr_b16 v[234:235], v34 offset:13568
    s_mov_b32 s18, 2621440
    s_mov_b32 s19, 0x20000
    s_mul_i32 s54, s46, 12928
    v_mfma_f32_32x32x16_bf16 v[96:111], v[224:227], v[164:167], v[96:111]
    ds_read_b64_tr_b16 v[236:237], v35 offset:13312
    s_cmp_eq_u32 s46, 3
    s_cselect_b32 s54, -26752, s54
    s_add_u32 m0, s54, 125088
    v_mfma_f32_32x32x16_bf16 v[112:127], v[228:231], v[164:167], v[112:127]
    ds_read_b64_tr_b16 v[238:239], v35 offset:13568
    s_add_u32 s55, s53, 0
    buffer_load_dwordx4 v22, s[16:19], s55 offen lds
    s_add_u32 m0, s54, 126112
    v_mfma_f32_32x32x16_bf16 v[128:143], v[224:227], v[176:179], v[128:143]
    s_add_u32 s55, s53, 1024
    buffer_load_dwordx4 v22, s[16:19], s55 offen lds
    s_add_u32 m0, s54, 127136
    v_mfma_f32_32x32x16_bf16 v[144:159], v[228:231], v[176:179], v[144:159]
    s_add_u32 s55, s53, 2048
    buffer_load_dwordx4 v22, s[16:19], s55 offen lds
    s_add_u32 m0, s54, 128160
    s_waitcnt lgkmcnt(0)
    v_mfma_f32_32x32x16_bf16 v[64:79], v[232:235], v[168:171], v[64:79]
    ds_read_b128 v[160:163], v28 offset:0
    ds_read_b128 v[164:167], v28 offset:4096
    s_add_u32 s55, s53, 3072
    buffer_load_dwordx4 v22, s[16:19], s55 offen lds
    v_mov_b32 v42, 0
    v_mfma_f32_32x32x16_bf16 v[80:95], v[236:239], v[168:171], v[80:95]
    ds_read_b64_tr_b16 v[240:241], v34 offset:14336
    ds_read_b64_tr_b16 v[242:243], v34 offset:14592
    v_mov_b32 v43, 0
    v_min_u32 v38, 7, v1
    v_lshlrev_b32 v38, 2, v38
    v_mfma_f32_32x32x16_bf16 v[96:111], v[232:235], v[172:175], v[96:111]
    ds_read_b64_tr_b16 v[244:245], v35 offset:14336
    v_add_u32 v38, s54, v38
    v_lshlrev_b32 v39, 3, v1
    v_add_u32 v39, s54, v39
    v_mfma_f32_32x32x16_bf16 v[112:127], v[236:239], v[172:175], v[112:127]
    ds_read_b64_tr_b16 v[246:247], v35 offset:14592
    v_add_u32 v39, 133376, v39
    v_add_u32 v38, 125056, v38
    ds_write_b64 v39, v[42:43]
    v_mfma_f32_32x32x16_bf16 v[128:143], v[232:235], v[176:179], v[128:143]
    ds_write_b32 v38, v42
    s_mul_i32 s94, s46, 12928
    s_add_u32 s94, s94, 125056
    v_mfma_f32_32x32x16_bf16 v[144:159], v[236:239], v[176:179], v[144:159]
    s_cmp_eq_u32 s46, 3
    s_cselect_b32 s94, 98304, s94
    s_lshl_b32 s52, s76, 12
    s_waitcnt lgkmcnt(2)
    v_mfma_f32_32x32x16_bf16 v[64:79], v[240:243], v[160:163], v[64:79]
    ds_read_b128 v[168:171], v29 offset:0
    ds_read_b128 v[172:175], v29 offset:4096
    s_add_u32 s52, s52, s51
    s_add_u32 s52, s52, 4521984
    s_add_u32 m0, s94, 8832
    v_mfma_f32_32x32x16_bf16 v[80:95], v[244:247], v[160:163], v[80:95]
    ds_read_b64_tr_b16 v[248:249], v34 offset:15360
    ds_read_b64_tr_b16 v[250:251], v34 offset:15616
    s_add_u32 s53, s52, 0
    buffer_load_dwordx4 v22, s[4:7], s53 offen sc1 lds
    s_add_u32 m0, s94, 9856
    v_mfma_f32_32x32x16_bf16 v[96:111], v[240:243], v[164:167], v[96:111]
    ds_read_b64_tr_b16 v[252:253], v35 offset:15360
    s_add_u32 s53, s52, 1024
    buffer_load_dwordx4 v22, s[4:7], s53 offen sc1 lds
    s_add_u32 m0, s94, 10880
    v_mfma_f32_32x32x16_bf16 v[112:127], v[244:247], v[164:167], v[112:127]
    ds_read_b64_tr_b16 v[254:255], v35 offset:15616
    s_add_u32 s53, s52, 2048
    buffer_load_dwordx4 v22, s[4:7], s53 offen sc1 lds
    s_add_u32 m0, s94, 11904
    v_mfma_f32_32x32x16_bf16 v[128:143], v[240:243], v[176:179], v[128:143]
    s_add_u32 s53, s52, 3072
    buffer_load_dwordx4 v22, s[4:7], s53 offen sc1 lds
    v_mfma_f32_32x32x16_bf16 v[144:159], v[244:247], v[176:179], v[144:159]
    s_waitcnt lgkmcnt(0)
    v_mfma_f32_32x32x16_bf16 v[64:79], v[248:251], v[168:171], v[64:79]
    v_mfma_f32_32x32x16_bf16 v[80:95], v[252:255], v[168:171], v[80:95]
    v_mfma_f32_32x32x16_bf16 v[96:111], v[248:251], v[172:175], v[96:111]
    v_mfma_f32_32x32x16_bf16 v[112:127], v[252:255], v[172:175], v[112:127]
    v_mfma_f32_32x32x16_bf16 v[128:143], v[248:251], v[176:179], v[128:143]
    v_mfma_f32_32x32x16_bf16 v[144:159], v[252:255], v[176:179], v[144:159]
    s_barrier
    v_lshrrev_b32 v36, 5, v1
    v_lshlrev_b32 v36, 7, v36
    s_mov_b32 exec_lo, 1
    s_mov_b32 exec_hi, 1
    s_nop 5
    ds_write_b128 v36, v[128:131] offset:49152
    ds_write_b128 v36, v[132:135] offset:49168
    ds_write_b128 v36, v[136:139] offset:49184
    ds_write_b128 v36, v[140:143] offset:49200
    ds_write_b128 v36, v[144:147] offset:49216
    ds_write_b128 v36, v[148:151] offset:49232
    ds_write_b128 v36, v[152:155] offset:49248
    ds_write_b128 v36, v[156:159] offset:49264
    s_mov_b64 exec, -1
    s_waitcnt vmcnt(8)
    s_waitcnt lgkmcnt(0)
L_epi:
    v_lshrrev_b32 v40, 5, v1
    v_lshlrev_b32 v40, 7, v40
    ds_read_b128 v[128:131], v40 offset:49152
    ds_read_b128 v[132:135], v40 offset:49168
    ds_read_b128 v[136:139], v40 offset:49184
    ds_read_b128 v[140:143], v40 offset:49200
    ds_read_b128 v[144:147], v40 offset:49216
    ds_read_b128 v[148:151], v40 offset:49232
    ds_read_b128 v[152:155], v40 offset:49248
    ds_read_b128 v[156:159], v40 offset:49264
    v_cmp_le_u32 s[82:83], 32, v1
    v_add_f32 v44, v44, v46
    v_add_f32 v45, v45, v47
    v_add_f32 v48, v48, v50
    v_add_f32 v49, v49, v51
    v_add_f32 v44, v44, v48
    v_add_f32 v45, v45, v49
    v_mov_b32 v40, v44
    s_nop 1
    v_permlane32_swap_b32 v40, v44
    v_add_f32 v44, v44, v40
    v_mov_b32 v40, v45
    s_nop 1
    v_permlane32_swap_b32 v40, v45
    v_add_f32 v45, v45, v40
    v_mul_f32 v44, 0x3acccccd, v44
    v_mul_f32 v45, 0x3acccccd, v45
    v_fma_f32 v45, -v44, v44, v45
    v_max_f32 v45, 0, v45
    v_add_f32 v45, 0x3727c5ac, v45
    v_rsq_f32 v170, v45
    v_sub_f32 v168, 0, v44
    v_mul_f32 v172, 0x3ea52b5c, v170
    v_cndmask_b32 v174, v172, v170, s[82:83]
    s_waitcnt lgkmcnt(0)
    v_and_b32 v40, 31, v1
    s_lshl_b32 s52, s46, 5
    v_add_u32 v40, s52, v40
    v_mul_u32_u24 v40, 48, v40
    v_lshrrev_b32 v41, 5, v1
    v_lshl_add_u32 v176, v41, 4, v40
    v_mul_u32_u24 v41, 12288, v41
    v_add3_u32 v177, v40, v41, 32
    v_pk_fma_f32 v[80:81], v[144:145], v[168:169], v[80:81] op_sel_hi:[1,0,1]
    s_nop 0
    v_pk_mul_f32 v[80:81], v[80:81], v[170:171] op_sel_hi:[1,0]
    s_nop 0
    v_cvt_pk_bf16_f32 v160, v80, v81
    v_pk_fma_f32 v[82:83], v[146:147], v[168:169], v[82:83] op_sel_hi:[1,0,1]
    s_nop 0
    v_pk_mul_f32 v[82:83], v[82:83], v[170:171] op_sel_hi:[1,0]
    s_nop 0
    v_cvt_pk_bf16_f32 v161, v82, v83
    v_pk_fma_f32 v[84:85], v[148:149], v[168:169], v[84:85] op_sel_hi:[1,0,1]
    s_nop 0
    v_pk_mul_f32 v[84:85], v[84:85], v[170:171] op_sel_hi:[1,0]
    s_nop 0
    v_cvt_pk_bf16_f32 v162, v84, v85
    v_pk_fma_f32 v[86:87], v[150:151], v[168:169], v[86:87] op_sel_hi:[1,0,1]
    s_nop 0
    v_pk_mul_f32 v[86:87], v[86:87], v[170:171] op_sel_hi:[1,0]
    s_nop 0
    v_cvt_pk_bf16_f32 v163, v86, v87
    v_pk_fma_f32 v[88:89], v[152:153], v[168:169], v[88:89] op_sel_hi:[1,0,1]
    s_nop 0
    v_pk_mul_f32 v[88:89], v[88:89], v[170:171] op_sel_hi:[1,0]
    s_nop 0
    v_cvt_pk_bf16_f32 v164, v88, v89
    v_pk_fma_f32 v[90:91], v[154:155], v[168:169], v[90:91] op_sel_hi:[1,0,1]
    s_nop 0
    v_pk_mul_f32 v[90:91], v[90:91], v[170:171] op_sel_hi:[1,0]
    s_nop 0
    v_cvt_pk_bf16_f32 v165, v90, v91
    v_pk_fma_f32 v[92:93], v[156:157], v[168:169], v[92:93] op_sel_hi:[1,0,1]
    s_nop 0
    v_pk_mul_f32 v[92:93], v[92:93], v[170:171] op_sel_hi:[1,0]
    s_nop 0
    v_cvt_pk_bf16_f32 v166, v92, v93
    v_pk_fma_f32 v[94:95], v[158:159], v[168:169], v[94:95] op_sel_hi:[1,0,1]
    s_nop 0
    v_pk_mul_f32 v[94:95], v[94:95], v[170:171] op_sel_hi:[1,0]
    s_nop 0
    v_cvt_pk_bf16_f32 v167, v94, v95
    ds_write_b128 v176, v[160:163] offset:0
    ds_write_b128 v176, v[164:167] offset:12288
    v_pk_fma_f32 v[64:65], v[128:129], v[168:169], v[64:65] op_sel_hi:[1,0,1]
    s_nop 0
    v_pk_mul_f32 v[64:65], v[64:65], v[172:173] op_sel_hi:[1,0]
    s_nop 0
    v_cvt_pk_bf16_f32 v24, v64, v65
    v_pk_fma_f32 v[66:67], v[130:131], v[168:169], v[66:67] op_sel_hi:[1,0,1]
    s_nop 0
    v_pk_mul_f32 v[66:67], v[66:67], v[172:173] op_sel_hi:[1,0]
    s_nop 0
    v_cvt_pk_bf16_f32 v25, v66, v67
    v_pk_fma_f32 v[68:69], v[132:133], v[168:169], v[68:69] op_sel_hi:[1,0,1]
    s_nop 0
    v_pk_mul_f32 v[68:69], v[68:69], v[172:173] op_sel_hi:[1,0]
    s_nop 0
    v_cvt_pk_bf16_f32 v26, v68, v69
    v_pk_fma_f32 v[70:71], v[134:135], v[168:169], v[70:71] op_sel_hi:[1,0,1]
    s_nop 0
    v_pk_mul_f32 v[70:71], v[70:71], v[172:173] op_sel_hi:[1,0]
    s_nop 0
    v_cvt_pk_bf16_f32 v27, v70, v71
    v_pk_fma_f32 v[72:73], v[136:137], v[168:169], v[72:73] op_sel_hi:[1,0,1]
    s_nop 0
    v_pk_mul_f32 v[72:73], v[72:73], v[174:175] op_sel_hi:[1,0]
    s_nop 0
    v_cvt_pk_bf16_f32 v42, v72, v73
    v_pk_fma_f32 v[74:75], v[138:139], v[168:169], v[74:75] op_sel_hi:[1,0,1]
    s_nop 0
    v_pk_mul_f32 v[74:75], v[74:75], v[174:175] op_sel_hi:[1,0]
    s_nop 0
    v_cvt_pk_bf16_f32 v43, v74, v75
    v_pk_fma_f32 v[76:77], v[140:141], v[168:169], v[76:77] op_sel_hi:[1,0,1]
    s_nop 0
    v_pk_mul_f32 v[76:77], v[76:77], v[170:171] op_sel_hi:[1,0]
    s_nop 0
    v_cvt_pk_bf16_f32 v44, v76, v77
    v_pk_fma_f32 v[78:79], v[142:143], v[168:169], v[78:79] op_sel_hi:[1,0,1]
    s_nop 0
    v_pk_mul_f32 v[78:79], v[78:79], v[170:171] op_sel_hi:[1,0]
    s_nop 0
    v_cvt_pk_bf16_f32 v45, v78, v79
    v_cndmask_b32 v180, v44, v42, s[82:83]
    v_cndmask_b32 v181, v45, v43, s[82:83]
    v_mov_b32 v182, 0x3f80
    v_cndmask_b32 v182, 0, v182, s[82:83]
    v_mov_b32 v183, 0
    v_cndmask_b32 v28, v42, 0, s[82:83]
    v_cndmask_b32 v29, v43, 0, s[82:83]
    v_mov_b32 v30, 0
    v_mov_b32 v31, 0
    ds_write_b128 v177, v[180:183]
    v_add_f32 v52, v52, v54
    v_add_f32 v53, v53, v55
    v_add_f32 v56, v56, v58
    v_add_f32 v57, v57, v59
    v_add_f32 v52, v52, v56
    v_add_f32 v53, v53, v57
    v_mov_b32 v40, v52
    s_nop 1
    v_permlane32_swap_b32 v40, v52
    v_add_f32 v52, v52, v40
    v_mov_b32 v40, v53
    s_nop 1
    v_permlane32_swap_b32 v40, v53
    v_add_f32 v53, v53, v40
    v_mul_f32 v52, 0x3acccccd, v52
    v_mul_f32 v53, 0x3acccccd, v53
    v_fma_f32 v53, -v52, v52, v53
    v_max_f32 v53, 0, v53
    v_add_f32 v53, 0x3727c5ac, v53
    v_rsq_f32 v170, v53
    v_sub_f32 v168, 0, v52
    v_mul_f32 v172, 0x3ea52b5c, v170
    v_cndmask_b32 v174, v172, v170, s[82:83]
    s_mul_i32 s52, s46, -3072
    s_add_u32 s52, s52, 10752
    v_add_u32 v176, s52, v176
    v_add_u32 v177, s52, v177
    v_pk_fma_f32 v[112:113], v[144:145], v[168:169], v[112:113] op_sel_hi:[1,0,1]
    s_nop 0
    v_pk_mul_f32 v[112:113], v[112:113], v[170:171] op_sel_hi:[1,0]
    s_nop 0
    v_cvt_pk_bf16_f32 v160, v112, v113
    v_pk_fma_f32 v[114:115], v[146:147], v[168:169], v[114:115] op_sel_hi:[1,0,1]
    s_nop 0
    v_pk_mul_f32 v[114:115], v[114:115], v[170:171] op_sel_hi:[1,0]
    s_nop 0
    v_cvt_pk_bf16_f32 v161, v114, v115
    v_pk_fma_f32 v[116:117], v[148:149], v[168:169], v[116:117] op_sel_hi:[1,0,1]
    s_nop 0
    v_pk_mul_f32 v[116:117], v[116:117], v[170:171] op_sel_hi:[1,0]
    s_nop 0
    v_cvt_pk_bf16_f32 v162, v116, v117
    v_pk_fma_f32 v[118:119], v[150:151], v[168:169], v[118:119] op_sel_hi:[1,0,1]
    s_nop 0
    v_pk_mul_f32 v[118:119], v[118:119], v[170:171] op_sel_hi:[1,0]
    s_nop 0
    v_cvt_pk_bf16_f32 v163, v118, v119
    v_pk_fma_f32 v[120:121], v[152:153], v[168:169], v[120:121] op_sel_hi:[1,0,1]
    s_nop 0
    v_pk_mul_f32 v[120:121], v[120:121], v[170:171] op_sel_hi:[1,0]
    s_nop 0
    v_cvt_pk_bf16_f32 v164, v120, v121
    v_pk_fma_f32 v[122:123], v[154:155], v[168:169], v[122:123] op_sel_hi:[1,0,1]
    s_nop 0
    v_pk_mul_f32 v[122:123], v[122:123], v[170:171] op_sel_hi:[1,0]
    s_nop 0
    v_cvt_pk_bf16_f32 v165, v122, v123
    v_pk_fma_f32 v[124:125], v[156:157], v[168:169], v[124:125] op_sel_hi:[1,0,1]
    s_nop 0
    v_pk_mul_f32 v[124:125], v[124:125], v[170:171] op_sel_hi:[1,0]
    s_nop 0
    v_cvt_pk_bf16_f32 v166, v124, v125
    v_pk_fma_f32 v[126:127], v[158:159], v[168:169], v[126:127] op_sel_hi:[1,0,1]
    s_nop 0
    v_pk_mul_f32 v[126:127], v[126:127], v[170:171] op_sel_hi:[1,0]
    s_nop 0
    v_cvt_pk_bf16_f32 v167, v126, v127
    ds_write_b128 v176, v[160:163] offset:0
    ds_write_b128 v176, v[164:167] offset:12288
    v_pk_fma_f32 v[96:97], v[128:129], v[168:169], v[96:97] op_sel_hi:[1,0,1]
    s_nop 0
    v_pk_mul_f32 v[96:97], v[96:97], v[172:173] op_sel_hi:[1,0]
    s_nop 0
    v_cvt_pk_bf16_f32 v32, v96, v97
    v_pk_fma_f32 v[98:99], v[130:131], v[168:169], v[98:99] op_sel_hi:[1,0,1]
    s_nop 0
    v_pk_mul_f32 v[98:99], v[98:99], v[172:173] op_sel_hi:[1,0]
    s_nop 0
    v_cvt_pk_bf16_f32 v33, v98, v99
    v_pk_fma_f32 v[100:101], v[132:133], v[168:169], v[100:101] op_sel_hi:[1,0,1]
    s_nop 0
    v_pk_mul_f32 v[100:101], v[100:101], v[172:173] op_sel_hi:[1,0]
    s_nop 0
    v_cvt_pk_bf16_f32 v34, v100, v101
    v_pk_fma_f32 v[102:103], v[134:135], v[168:169], v[102:103] op_sel_hi:[1,0,1]
    s_nop 0
    v_pk_mul_f32 v[102:103], v[102:103], v[172:173] op_sel_hi:[1,0]
    s_nop 0
    v_cvt_pk_bf16_f32 v35, v102, v103
    v_pk_fma_f32 v[104:105], v[136:137], v[168:169], v[104:105] op_sel_hi:[1,0,1]
    s_nop 0
    v_pk_mul_f32 v[104:105], v[104:105], v[174:175] op_sel_hi:[1,0]
    s_nop 0
    v_cvt_pk_bf16_f32 v42, v104, v105
    v_pk_fma_f32 v[106:107], v[138:139], v[168:169], v[106:107] op_sel_hi:[1,0,1]
    s_nop 0
    v_pk_mul_f32 v[106:107], v[106:107], v[174:175] op_sel_hi:[1,0]
    s_nop 0
    v_cvt_pk_bf16_f32 v43, v106, v107
    v_pk_fma_f32 v[108:109], v[140:141], v[168:169], v[108:109] op_sel_hi:[1,0,1]
    s_nop 0
    v_pk_mul_f32 v[108:109], v[108:109], v[170:171] op_sel_hi:[1,0]
    s_nop 0
    v_cvt_pk_bf16_f32 v44, v108, v109
    v_pk_fma_f32 v[110:111], v[142:143], v[168:169], v[110:111] op_sel_hi:[1,0,1]
    s_nop 0
    v_pk_mul_f32 v[110:111], v[110:111], v[170:171] op_sel_hi:[1,0]
    s_nop 0
    v_cvt_pk_bf16_f32 v45, v110, v111
    v_cndmask_b32 v180, v44, v42, s[82:83]
    v_cndmask_b32 v181, v45, v43, s[82:83]
    v_mov_b32 v182, 0x3f80
    v_cndmask_b32 v182, 0, v182, s[82:83]
    v_mov_b32 v183, 0
    v_cndmask_b32 v36, v42, 0, s[82:83]
    v_cndmask_b32 v37, v43, 0, s[82:83]
    v_mov_b32 v38, 0
    v_mov_b32 v39, 0
    ds_write_b128 v177, v[180:183]
    s_waitcnt lgkmcnt(0)
    s_barrier
    s_cmp_eq_u32 s49, 0
    s_cbranch_scc1 L_pois
    s_cmp_eq_u32 s44, 7
    s_cbranch_scc1 Lhp_6
    s_mul_i32 s53, s46, 6
    s_lshl_b32 s53, s53, 10
    v_add_u32 v59, s53, v22
    ds_read_b128 v[96:99], v59 offset:0
    ds_read_b128 v[100:103], v59 offset:1024
    ds_read_b128 v[104:107], v59 offset:2048
    ds_read_b128 v[108:111], v59 offset:3072
    ds_read_b128 v[112:115], v59 offset:4096
    ds_read_b128 v[116:119], v59 offset:5120
    s_lshl_b32 s52, s49, 3
    s_add_u32 s52, s52, s44
    s_lshl_b32 s52, s52, 5
    s_add_u32 s52, s52, s45
    s_mul_i32 s52, s52, 24576
    s_add_u32 s52, s52, 12582912
    s_waitcnt lgkmcnt(5)
    buffer_store_dwordx4 v[96:99], v59, s[4:7], s52 offen offset:0 sc1
    s_waitcnt lgkmcnt(4)
    buffer_store_dwordx4 v[100:103], v59, s[4:7], s52 offen offset:1024 sc1
    s_waitcnt lgkmcnt(3)
    buffer_store_dwordx4 v[104:107], v59, s[4:7], s52 offen offset:2048 sc1
    s_waitcnt lgkmcnt(2)
    buffer_store_dwordx4 v[108:111], v59, s[4:7], s52 offen offset:3072 sc1
    s_waitcnt lgkmcnt(1)
    s_add_u32 s52, s52, 4096
    buffer_store_dwordx4 v[112:115], v59, s[4:7], s52 offen offset:0 sc1
    s_waitcnt lgkmcnt(0)
    buffer_store_dwordx4 v[116:119], v59, s[4:7], s52 offen offset:1024 sc1
Lhp_6:
    s_branch L_nopub
L_pois:
    v_mov_b32 v96, -1
    v_mov_b32 v97, -1
    v_mov_b32 v98, -1
    v_mov_b32 v99, -1
    s_add_u32 s52, s44, 8
    s_lshl_b32 s52, s52, 5
    s_add_u32 s52, s52, s45
    s_mul_i32 s52, s52, 24576
    s_mul_i32 s53, s46, 6144
    s_add_u32 s52, s52, s53
    s_add_u32 s52, s52, 12582912
    buffer_store_dwordx4 v[96:99], v22, s[4:7], s52 offen offset:0 sc1
    buffer_store_dwordx4 v[96:99], v22, s[4:7], s52 offen offset:1024 sc1
    buffer_store_dwordx4 v[96:99], v22, s[4:7], s52 offen offset:2048 sc1
    buffer_store_dwordx4 v[96:99], v22, s[4:7], s52 offen offset:3072 sc1
    s_add_u32 s52, s52, 4096
    buffer_store_dwordx4 v[96:99], v22, s[4:7], s52 offen offset:0 sc1
    buffer_store_dwordx4 v[96:99], v22, s[4:7], s52 offen offset:1024 sc1
L_nopub:
    s_mov_b32 s87, s46
    s_sub_u32 s88, 7, s46
    v_and_b32 v46, 31, v1
    v_mul_u32_u24 v46, 48, v46
    v_lshrrev_b32 v47, 5, v1
    v_lshl_add_u32 v44, v47, 4, v46
    v_bfe_u32 v46, v1, 2, 2
    v_lshl_add_u32 v46, v47, 2, v46
    v_mul_u32_u24 v46, 48, v46
    v_bfe_u32 v47, v1, 4, 1
    v_lshl_add_u32 v46, v47, 5, v46
    v_and_b32 v47, 3, v1
    v_lshl_add_u32 v46, v47, 3, v46
    v_add_u32 v45, 12288, v46
    ds_read_b128 v[144:147], v22 offset:50688
    ds_read_b128 v[148:151], v22 offset:51712
    ds_read_b128 v[152:155], v22 offset:52736
    ds_read_b128 v[156:159], v22 offset:53760
    s_mov_b32 s85, -1536
    s_mul_i32 s52, s88, 1536
    v_add_u32 v40, s52, v44
    v_add_u32 v41, s52, v45
    s_mul_i32 s52, s87, 1536
    v_add_u32 v42, s52, v44
    v_add_u32 v43, s52, v45
    ds_read_b128 v[136:139], v40
    ds_read_b128 v[140:143], v40 offset:32
    ds_read_b128 v[176:179], v42
    ds_read_b128 v[180:183], v42 offset:32
    s_waitcnt lgkmcnt(2)
    v_mfma_f32_32x32x16_bf16 v[96:111], v[136:139], v[32:35], v[144:159]
    v_mfma_f32_32x32x16_bf16 v[96:111], v[140:143], v[36:39], v[96:111]
    s_waitcnt lgkmcnt(0)
    v_mfma_f32_32x32x16_bf16 v[160:175], v[176:179], v[24:27], v[144:159]
    v_mfma_f32_32x32x16_bf16 v[160:175], v[180:183], v[28:31], v[160:175]
    s_nop 5
    ds_read_b64_tr_b16 v[144:145], v41 offset:0
    ds_read_b64_tr_b16 v[146:147], v41 offset:384
    ds_read_b64_tr_b16 v[148:149], v41 offset:768
    ds_read_b64_tr_b16 v[150:151], v41 offset:1152
    s_cmp_eq_u32 s49, 0
    s_cbranch_scc0 Loa_7
    v_and_b32 v46, 31, v1
    v_lshrrev_b32 v47, 4, v46
    v_mul_u32_u24 v47, 20480, v47
    v_and_b32 v46, 15, v46
    v_lshl_add_u32 v46, v46, 4, v47
    s_mul_i32 s52, s45, 5
    v_lshrrev_b32 v47, 5, v1
    v_add_u32 v47, s52, v47
    v_add_u32 v48, 0, v47
    v_lshrrev_b32 v49, 3, v48
    v_lshl_add_u32 v49, v49, 10, v46
    v_bfe_u32 v50, v48, 2, 1
    v_lshl_add_u32 v49, v50, 9, v49
    v_and_b32 v50, 1, v48
    v_lshl_add_u32 v49, v50, 8, v49
    v_bfe_u32 v50, v48, 1, 1
    v_lshl_add_u32 v189, v50, 3, v49
    v_add_u32 v48, 2, v47
    v_lshrrev_b32 v49, 3, v48
    v_lshl_add_u32 v49, v49, 10, v46
    v_bfe_u32 v50, v48, 2, 1
    v_lshl_add_u32 v49, v50, 9, v49
    v_and_b32 v50, 1, v48
    v_lshl_add_u32 v49, v50, 8, v49
    v_bfe_u32 v50, v48, 1, 1
    v_lshl_add_u32 v190, v50, 3, v49
    v_add_u32 v48, 4, v47
    v_lshrrev_b32 v49, 3, v48
    v_lshl_add_u32 v49, v49, 10, v46
    v_bfe_u32 v50, v48, 2, 1
    v_lshl_add_u32 v49, v50, 9, v49
    v_and_b32 v50, 1, v48
    v_lshl_add_u32 v49, v50, 8, v49
    v_bfe_u32 v50, v48, 1, 1
    v_lshl_add_u32 v191, v50, 3, v49
Loa_7:
    v_mov_b32 v128, 0
    v_mov_b32 v129, 0
    v_mov_b32 v130, 0
    v_mov_b32 v131, 0
    s_nop 1
    v_mfma_f32_32x32x16_bf16 v[64:79], v[136:139], v[128:131], 0
    v_mfma_f32_32x32x16_bf16 v[80:95], v[136:139], v[128:131], 0
    s_add_u32 s86, s88, 1
    v_add_u32 v40, s85, v40
    v_add_u32 v41, s85, v41
    s_sub_u32 s86, s86, 1
    s_cmp_eq_u32 s86, 0
    s_cbranch_scc1 Latt_8_last0
Latt_8_loop:
    ds_read_b128 v[136:139], v40
    ds_read_b128 v[140:143], v40 offset:32
    ds_read_b64_tr_b16 v[152:153], v41 offset:0
    ds_read_b64_tr_b16 v[154:155], v41 offset:384
    ds_read_b64_tr_b16 v[156:157], v41 offset:768
    ds_read_b64_tr_b16 v[158:159], v41 offset:1152
    s_sub_u32 s86, s86, 1
    s_cmp_eq_u32 s86, 0
    v_exp_f32 v96, v96
    v_exp_f32 v97, v97
    v_exp_f32 v98, v98
    v_exp_f32 v99, v99
    v_exp_f32 v100, v100
    v_exp_f32 v101, v101
    v_exp_f32 v102, v102
    v_exp_f32 v103, v103
    s_waitcnt lgkmcnt(4)
    v_mfma_f32_32x32x16_bf16 v[112:127], v[136:139], v[32:35], 0
    v_cvt_pk_bf16_f32 v128, v96, v97
    v_cvt_pk_bf16_f32 v129, v98, v99
    v_cvt_pk_bf16_f32 v130, v100, v101
    v_cvt_pk_bf16_f32 v131, v102, v103
    v_exp_f32 v104, v104
    v_exp_f32 v105, v105
    v_exp_f32 v106, v106
    v_exp_f32 v107, v107
    v_mfma_f32_32x32x16_bf16 v[112:127], v[140:143], v[36:39], v[112:127]
    v_exp_f32 v108, v108
    v_exp_f32 v109, v109
    v_exp_f32 v110, v110
    v_exp_f32 v111, v111
    v_mfma_f32_32x32x16_bf16 v[80:95], v[144:147], v[128:131], v[80:95]
    v_cvt_pk_bf16_f32 v132, v104, v105
    v_cvt_pk_bf16_f32 v133, v106, v107
    v_cvt_pk_bf16_f32 v134, v108, v109
    v_cvt_pk_bf16_f32 v135, v110, v111
    v_add_u32 v40, s85, v40
    v_add_u32 v41, s85, v41
    v_mfma_f32_32x32x16_bf16 v[80:95], v[148:151], v[132:135], v[80:95]
    s_cbranch_scc1 Latt_8_last1
    ds_read_b128 v[136:139], v40
    ds_read_b128 v[140:143], v40 offset:32
    ds_read_b64_tr_b16 v[144:145], v41 offset:0
    ds_read_b64_tr_b16 v[146:147], v41 offset:384
    ds_read_b64_tr_b16 v[148:149], v41 offset:768
    ds_read_b64_tr_b16 v[150:151], v41 offset:1152
    s_sub_u32 s86, s86, 1
    s_cmp_eq_u32 s86, 0
    v_exp_f32 v112, v112
    v_exp_f32 v113, v113
    v_exp_f32 v114, v114
    v_exp_f32 v115, v115
    v_exp_f32 v116, v116
    v_exp_f32 v117, v117
    v_exp_f32 v118, v118
    v_exp_f32 v119, v119
    s_waitcnt lgkmcnt(4)
    v_mfma_f32_32x32x16_bf16 v[96:111], v[136:139], v[32:35], 0
    v_cvt_pk_bf16_f32 v128, v112, v113
    v_cvt_pk_bf16_f32 v129, v114, v115
    v_cvt_pk_bf16_f32 v130, v116, v117
    v_cvt_pk_bf16_f32 v131, v118, v119
    v_exp_f32 v120, v120
    v_exp_f32 v121, v121
    v_exp_f32 v122, v122
    v_exp_f32 v123, v123
    v_mfma_f32_32x32x16_bf16 v[96:111], v[140:143], v[36:39], v[96:111]
    v_exp_f32 v124, v124
    v_exp_f32 v125, v125
    v_exp_f32 v126, v126
    v_exp_f32 v127, v127
    v_mfma_f32_32x32x16_bf16 v[80:95], v[152:155], v[128:131], v[80:95]
    v_cvt_pk_bf16_f32 v132, v120, v121
    v_cvt_pk_bf16_f32 v133, v122, v123
    v_cvt_pk_bf16_f32 v134, v124, v125
    v_cvt_pk_bf16_f32 v135, v126, v127
    v_add_u32 v40, s85, v40
    v_add_u32 v41, s85, v41
    v_mfma_f32_32x32x16_bf16 v[80:95], v[156:159], v[132:135], v[80:95]
    s_cbranch_scc0 Latt_8_loop
Latt_8_last0:
    v_exp_f32 v96, v96
    v_exp_f32 v97, v97
    v_exp_f32 v98, v98
    v_exp_f32 v99, v99
    v_exp_f32 v100, v100
    v_exp_f32 v101, v101
    v_exp_f32 v102, v102
    v_exp_f32 v103, v103
    v_cvt_pk_bf16_f32 v128, v96, v97
    v_cvt_pk_bf16_f32 v129, v98, v99
    v_cvt_pk_bf16_f32 v130, v100, v101
    v_cvt_pk_bf16_f32 v131, v102, v103
    v_exp_f32 v104, v104
    v_exp_f32 v105, v105
    v_exp_f32 v106, v106
    v_exp_f32 v107, v107
    v_exp_f32 v108, v108
    v_exp_f32 v109, v109
    v_exp_f32 v110, v110
    v_exp_f32 v111, v111
    s_waitcnt lgkmcnt(0)
    v_mfma_f32_32x32x16_bf16 v[80:95], v[144:147], v[128:131], v[80:95]
    v_cvt_pk_bf16_f32 v132, v104, v105
    v_cvt_pk_bf16_f32 v133, v106, v107
    v_cvt_pk_bf16_f32 v134, v108, v109
    v_cvt_pk_bf16_f32 v135, v110, v111
    s_nop 1
    v_mfma_f32_32x32x16_bf16 v[80:95], v[148:151], v[132:135], v[80:95]
    s_branch Latt_8_done
Latt_8_last1:
    v_exp_f32 v112, v112
    v_exp_f32 v113, v113
    v_exp_f32 v114, v114
    v_exp_f32 v115, v115
    v_exp_f32 v116, v116
    v_exp_f32 v117, v117
    v_exp_f32 v118, v118
    v_exp_f32 v119, v119
    v_cvt_pk_bf16_f32 v128, v112, v113
    v_cvt_pk_bf16_f32 v129, v114, v115
    v_cvt_pk_bf16_f32 v130, v116, v117
    v_cvt_pk_bf16_f32 v131, v118, v119
    v_exp_f32 v120, v120
    v_exp_f32 v121, v121
    v_exp_f32 v122, v122
    v_exp_f32 v123, v123
    v_exp_f32 v124, v124
    v_exp_f32 v125, v125
    v_exp_f32 v126, v126
    v_exp_f32 v127, v127
    s_waitcnt lgkmcnt(0)
    v_mfma_f32_32x32x16_bf16 v[80:95], v[152:155], v[128:131], v[80:95]
    v_cvt_pk_bf16_f32 v132, v120, v121
    v_cvt_pk_bf16_f32 v133, v122, v123
    v_cvt_pk_bf16_f32 v134, v124, v125
    v_cvt_pk_bf16_f32 v135, v126, v127
    s_nop 1
    v_mfma_f32_32x32x16_bf16 v[80:95], v[156:159], v[132:135], v[80:95]
Latt_8_done:
    ds_read_b64_tr_b16 v[144:145], v43 offset:0
    ds_read_b64_tr_b16 v[146:147], v43 offset:384
    ds_read_b64_tr_b16 v[148:149], v43 offset:768
    ds_read_b64_tr_b16 v[150:151], v43 offset:1152
    s_cmp_eq_u32 s49, 0
    s_cbranch_scc1 Lob_9_l0
    s_cmp_eq_u32 s44, 0
    s_cbranch_scc1 Lob_9
    s_add_u32 s52, s44, 7
    s_lshl_b32 s52, s52, 5
    s_add_u32 s52, s52, s45
    s_mul_i32 s80, s52, 24576
    s_mul_i32 s81, s46, 6144
    s_add_u32 s80, s80, s81
    s_add_u32 s80, s80, 12582912
    s_add_u32 m0, s81, 24576
    s_add_u32 s55, s80, 0
    buffer_load_dwordx4 v22, s[4:7], s55 offen sc1 lds
    s_add_u32 m0, s81, 25600
    s_add_u32 s55, s80, 1024
    buffer_load_dwordx4 v22, s[4:7], s55 offen sc1 lds
    s_add_u32 m0, s81, 26624
    s_add_u32 s55, s80, 2048
    buffer_load_dwordx4 v22, s[4:7], s55 offen sc1 lds
    s_add_u32 m0, s81, 27648
    s_add_u32 s55, s80, 3072
    buffer_load_dwordx4 v22, s[4:7], s55 offen sc1 lds
    s_add_u32 m0, s81, 28672
    s_add_u32 s55, s80, 4096
    buffer_load_dwordx4 v22, s[4:7], s55 offen sc1 lds
    s_add_u32 m0, s81, 29696
    s_add_u32 s55, s80, 5120
    buffer_load_dwordx4 v22, s[4:7], s55 offen sc1 lds
    s_branch Lob_9
Lob_9_l0:
    s_waitcnt vmcnt(0)
    v_mov_b32 v46, 1
    v_mov_b32 v47, 49408
    s_mov_b64 exec, 1
    ds_add_rtn_u32 v46, v47, v46
    s_mov_b64 exec, -1
    s_waitcnt lgkmcnt(0)
    v_readfirstlane_b32 s56, v46
    s_nop 0
    s_cmp_eq_u32 s56, 3
Lob_9:
    s_add_u32 s86, s87, 1
    v_add_u32 v42, s85, v42
    v_add_u32 v43, s85, v43
    s_sub_u32 s86, s86, 1
    s_cmp_eq_u32 s86, 0
    s_cbranch_scc1 Latt_10_last0
Latt_10_loop:
    ds_read_b128 v[136:139], v42
    ds_read_b128 v[140:143], v42 offset:32
    ds_read_b64_tr_b16 v[152:153], v43 offset:0
    ds_read_b64_tr_b16 v[154:155], v43 offset:384
    ds_read_b64_tr_b16 v[156:157], v43 offset:768
    ds_read_b64_tr_b16 v[158:159], v43 offset:1152
    s_sub_u32 s86, s86, 1
    s_cmp_eq_u32 s86, 0
    v_exp_f32 v160, v160
    v_exp_f32 v161, v161
    v_exp_f32 v162, v162
    v_exp_f32 v163, v163
    v_exp_f32 v164, v164
    v_exp_f32 v165, v165
    v_exp_f32 v166, v166
    v_exp_f32 v167, v167
    s_waitcnt lgkmcnt(4)
    v_mfma_f32_32x32x16_bf16 v[112:127], v[136:139], v[24:27], 0
    v_cvt_pk_bf16_f32 v128, v160, v161
    v_cvt_pk_bf16_f32 v129, v162, v163
    v_cvt_pk_bf16_f32 v130, v164, v165
    v_cvt_pk_bf16_f32 v131, v166, v167
    v_exp_f32 v168, v168
    v_exp_f32 v169, v169
    v_exp_f32 v170, v170
    v_exp_f32 v171, v171
    v_mfma_f32_32x32x16_bf16 v[112:127], v[140:143], v[28:31], v[112:127]
    v_exp_f32 v172, v172
    v_exp_f32 v173, v173
    v_exp_f32 v174, v174
    v_exp_f32 v175, v175
    v_mfma_f32_32x32x16_bf16 v[64:79], v[144:147], v[128:131], v[64:79]
    v_cvt_pk_bf16_f32 v132, v168, v169
    v_cvt_pk_bf16_f32 v133, v170, v171
    v_cvt_pk_bf16_f32 v134, v172, v173
    v_cvt_pk_bf16_f32 v135, v174, v175
    v_add_u32 v42, s85, v42
    v_add_u32 v43, s85, v43
    v_mfma_f32_32x32x16_bf16 v[64:79], v[148:151], v[132:135], v[64:79]
    s_cbranch_scc1 Latt_10_last1
    ds_read_b128 v[136:139], v42
    ds_read_b128 v[140:143], v42 offset:32
    ds_read_b64_tr_b16 v[144:145], v43 offset:0
    ds_read_b64_tr_b16 v[146:147], v43 offset:384
    ds_read_b64_tr_b16 v[148:149], v43 offset:768
    ds_read_b64_tr_b16 v[150:151], v43 offset:1152
    s_sub_u32 s86, s86, 1
    s_cmp_eq_u32 s86, 0
    v_exp_f32 v112, v112
    v_exp_f32 v113, v113
    v_exp_f32 v114, v114
    v_exp_f32 v115, v115
    v_exp_f32 v116, v116
    v_exp_f32 v117, v117
    v_exp_f32 v118, v118
    v_exp_f32 v119, v119
    s_waitcnt lgkmcnt(4)
    v_mfma_f32_32x32x16_bf16 v[160:175], v[136:139], v[24:27], 0
    v_cvt_pk_bf16_f32 v128, v112, v113
    v_cvt_pk_bf16_f32 v129, v114, v115
    v_cvt_pk_bf16_f32 v130, v116, v117
    v_cvt_pk_bf16_f32 v131, v118, v119
    v_exp_f32 v120, v120
    v_exp_f32 v121, v121
    v_exp_f32 v122, v122
    v_exp_f32 v123, v123
    v_mfma_f32_32x32x16_bf16 v[160:175], v[140:143], v[28:31], v[160:175]
    v_exp_f32 v124, v124
    v_exp_f32 v125, v125
    v_exp_f32 v126, v126
    v_exp_f32 v127, v127
    v_mfma_f32_32x32x16_bf16 v[64:79], v[152:155], v[128:131], v[64:79]
    v_cvt_pk_bf16_f32 v132, v120, v121
    v_cvt_pk_bf16_f32 v133, v122, v123
    v_cvt_pk_bf16_f32 v134, v124, v125
    v_cvt_pk_bf16_f32 v135, v126, v127
    v_add_u32 v42, s85, v42
    v_add_u32 v43, s85, v43
    v_mfma_f32_32x32x16_bf16 v[64:79], v[156:159], v[132:135], v[64:79]
    s_cbranch_scc0 Latt_10_loop
Latt_10_last0:
    v_exp_f32 v160, v160
    v_exp_f32 v161, v161
    v_exp_f32 v162, v162
    v_exp_f32 v163, v163
    v_exp_f32 v164, v164
    v_exp_f32 v165, v165
    v_exp_f32 v166, v166
    v_exp_f32 v167, v167
    v_cvt_pk_bf16_f32 v128, v160, v161
    v_cvt_pk_bf16_f32 v129, v162, v163
    v_cvt_pk_bf16_f32 v130, v164, v165
    v_cvt_pk_bf16_f32 v131, v166, v167
    v_exp_f32 v168, v168
    v_exp_f32 v169, v169
    v_exp_f32 v170, v170
    v_exp_f32 v171, v171
    v_exp_f32 v172, v172
    v_exp_f32 v173, v173
    v_exp_f32 v174, v174
    v_exp_f32 v175, v175
    s_waitcnt lgkmcnt(0)
    v_mfma_f32_32x32x16_bf16 v[64:79], v[144:147], v[128:131], v[64:79]
    v_cvt_pk_bf16_f32 v132, v168, v169
    v_cvt_pk_bf16_f32 v133, v170, v171
    v_cvt_pk_bf16_f32 v134, v172, v173
    v_cvt_pk_bf16_f32 v135, v174, v175
    s_nop 1
    v_mfma_f32_32x32x16_bf16 v[64:79], v[148:151], v[132:135], v[64:79]
    s_branch Latt_10_done
Latt_10_last1:
    v_exp_f32 v112, v112
    v_exp_f32 v113, v113
    v_exp_f32 v114, v114
    v_exp_f32 v115, v115
    v_exp_f32 v116, v116
    v_exp_f32 v117, v117
    v_exp_f32 v118, v118
    v_exp_f32 v119, v119
    v_cvt_pk_bf16_f32 v128, v112, v113
    v_cvt_pk_bf16_f32 v129, v114, v115
    v_cvt_pk_bf16_f32 v130, v116, v117
    v_cvt_pk_bf16_f32 v131, v118, v119
    v_exp_f32 v120, v120
    v_exp_f32 v121, v121
    v_exp_f32 v122, v122
    v_exp_f32 v123, v123
    v_exp_f32 v124, v124
    v_exp_f32 v125, v125
    v_exp_f32 v126, v126
    v_exp_f32 v127, v127
    s_waitcnt lgkmcnt(0)
    v_mfma_f32_32x32x16_bf16 v[64:79], v[152:155], v[128:131], v[64:79]
    v_cvt_pk_bf16_f32 v132, v120, v121
    v_cvt_pk_bf16_f32 v133, v122, v123
    v_cvt_pk_bf16_f32 v134, v124, v125
    v_cvt_pk_bf16_f32 v135, v126, v127
    s_nop 1
    v_mfma_f32_32x32x16_bf16 v[64:79], v[156:159], v[132:135], v[64:79]
Latt_10_done:
    s_cmp_eq_u32 s49, 0
    s_cbranch_scc0 L_mid1
    s_cmp_lt_u32 s46, s77
    s_cbranch_scc0 L_noconv
    s_mul_i32 s52, s46, 12928
    s_add_u32 s52, s52, 125056
    v_add_u32 v46, s52, v22
    v_lshlrev_b32 v47, 2, v1
    v_add_u32 v47, s52, v47
    s_waitcnt lgkmcnt(0)
    ds_read_b128 v[96:99], v46 offset:32
    ds_read_b32 v100, v46 offset:48
    ds_read_b128 v[104:107], v46 offset:1056
    ds_read_b32 v108, v46 offset:1072
    ds_read_b128 v[112:115], v46 offset:2080
    ds_read_b32 v116, v46 offset:2096
    ds_read_b128 v[120:123], v46 offset:3104
    ds_read_b32 v124, v46 offset:3120
    ds_read_b32 v128, v47
    ds_read_b32 v129, v47 offset:4
    s_waitcnt lgkmcnt(8)
    v_alignbit_b32 v96, v97, v96, 16
    v_alignbit_b32 v97, v98, v97, 16
    v_alignbit_b32 v98, v99, v98, 16
    v_alignbit_b32 v99, v100, v99, 16
    ds_write_b128 v46, v[96:99] offset:4192
    s_waitcnt lgkmcnt(6)
    v_alignbit_b32 v104, v105, v104, 16
    v_alignbit_b32 v105, v106, v105, 16
    v_alignbit_b32 v106, v107, v106, 16
    v_alignbit_b32 v107, v108, v107, 16
    ds_write_b128 v46, v[104:107] offset:5216
    s_waitcnt lgkmcnt(4)
    v_alignbit_b32 v112, v113, v112, 16
    v_alignbit_b32 v113, v114, v113, 16
    v_alignbit_b32 v114, v115, v114, 16
    v_alignbit_b32 v115, v116, v115, 16
    ds_write_b128 v46, v[112:115] offset:6240
    s_waitcnt lgkmcnt(2)
    v_alignbit_b32 v120, v121, v120, 16
    v_alignbit_b32 v121, v122, v121, 16
    v_alignbit_b32 v122, v123, v122, 16
    v_alignbit_b32 v123, v124, v123, 16
    ds_write_b128 v46, v[120:123] offset:7264
    s_waitcnt lgkmcnt(4)
    v_alignbit_b32 v128, v129, v128, 16
    s_mov_b64 exec, 0xff
    ds_write_b32 v47, v128 offset:4160
    s_mov_b64 exec, -1
    s_mul_i32 s94, s46, 12928
    s_add_u32 s94, s94, 125056
    v_and_b32 v46, 15, v1
    v_lshrrev_b32 v47, 4, v1
    v_lshlrev_b32 v48, 3, v47
    v_sub_u32 v48, v46, v48
    v_add_u32 v48, 9, v48
    v_ashrrev_i32 v48, 1, v48
    v_lshlrev_b32 v48, 2, v48
    v_and_b32 v49, 1, v46
    v_xor_b32 v49, 1, v49
    v_mul_u32_u24 v49, 4160, v49
    v_add3_u32 v40, v48, v49, 32
    v_add_u32 v40, s94, v40
    v_lshlrev_b32 v48, 5, v46
    v_lshl_add_u32 v48, v47, 4, v48
    v_add_u32 v48, 8800, v48
    v_add_u32 v42, s94, v48
    s_waitcnt lgkmcnt(0)
    ds_read2_b32 v[128:129], v40 offset0:0 offset1:1
    ds_read2_b32 v[130:131], v40 offset0:2 offset1:3
    ds_read_b128 v[172:175], v42 offset:3584
    ds_read_b128 v[168:171], v42 offset:3072
    ds_read_b128 v[164:167], v42 offset:2560
    ds_read_b128 v[160:163], v42 offset:2048
    ds_read_b128 v[156:159], v42 offset:1536
    ds_read_b128 v[152:155], v42 offset:1024
    ds_read_b128 v[148:151], v42 offset:512
    ds_read_b128 v[144:147], v42 offset:0
    v_subrev_u32 v42, 64, v42
    v_add_u32 v41, 512, v40
    ds_read2_b32 v[132:133], v41 offset0:0 offset1:1
    ds_read2_b32 v[134:135], v41 offset0:2 offset1:3
    v_add_u32 v41, 1024, v40
    ds_read2_b32 v[136:137], v41 offset0:0 offset1:1
    ds_read2_b32 v[138:139], v41 offset0:2 offset1:3
    v_add_u32 v41, 1536, v40
    ds_read2_b32 v[140:141], v41 offset0:0 offset1:1
    ds_read2_b32 v[142:143], v41 offset0:2 offset1:3
    v_add_u32 v41, 2048, v40
    ds_read2_b32 v[176:177], v41 offset0:0 offset1:1
    ds_read2_b32 v[178:179], v41 offset0:2 offset1:3
    v_add_u32 v41, 2560, v40
    ds_read2_b32 v[180:181], v41 offset0:0 offset1:1
    ds_read2_b32 v[182:183], v41 offset0:2 offset1:3
    v_add_u32 v41, 3072, v40
    ds_read2_b32 v[48:49], v41 offset0:0 offset1:1
    ds_read2_b32 v[50:51], v41 offset0:2 offset1:3
    v_add_u32 v41, 3584, v40
    ds_read2_b32 v[52:53], v41 offset0:0 offset1:1
    ds_read2_b32 v[54:55], v41 offset0:2 offset1:3
    v_add_u32 v40, 64, v40
    s_waitcnt lgkmcnt(15)
    v_mfma_f32_16x16x32_bf16 v[124:127], v[128:131], v[172:175], 0
    v_mfma_f32_16x16x32_bf16 v[120:123], v[128:131], v[168:171], 0
    v_mfma_f32_16x16x32_bf16 v[116:119], v[128:131], v[164:167], 0
    v_mfma_f32_16x16x32_bf16 v[112:115], v[128:131], v[160:163], 0
    v_mfma_f32_16x16x32_bf16 v[108:111], v[128:131], v[156:159], 0
    v_mfma_f32_16x16x32_bf16 v[104:107], v[128:131], v[152:155], 0
    v_mfma_f32_16x16x32_bf16 v[100:103], v[128:131], v[148:151], 0
    s_waitcnt lgkmcnt(14)
    v_mfma_f32_16x16x32_bf16 v[96:99], v[128:131], v[144:147], 0
    ds_read_b128 v[172:175], v42 offset:3584
    s_waitcnt lgkmcnt(13)
    v_mfma_f32_16x16x32_bf16 v[124:127], v[132:135], v[168:171], v[124:127]
    ds_read2_b32 v[128:129], v40 offset0:0 offset1:1
    ds_read2_b32 v[130:131], v40 offset0:2 offset1:3
    v_mfma_f32_16x16x32_bf16 v[120:123], v[132:135], v[164:167], v[120:123]
    v_mfma_f32_16x16x32_bf16 v[116:119], v[132:135], v[160:163], v[116:119]
    v_mfma_f32_16x16x32_bf16 v[112:115], v[132:135], v[156:159], v[112:115]
    v_mfma_f32_16x16x32_bf16 v[108:111], v[132:135], v[152:155], v[108:111]
    v_mfma_f32_16x16x32_bf16 v[104:107], v[132:135], v[148:151], v[104:107]
    v_mfma_f32_16x16x32_bf16 v[100:103], v[132:135], v[144:147], v[100:103]
    ds_read_b128 v[168:171], v42 offset:3072
    s_waitcnt lgkmcnt(14)
    v_mfma_f32_16x16x32_bf16 v[124:127], v[136:139], v[164:167], v[124:127]
    v_add_u32 v41, 512, v40
    ds_read2_b32 v[132:133], v41 offset0:0 offset1:1
    ds_read2_b32 v[134:135], v41 offset0:2 offset1:3
    v_mfma_f32_16x16x32_bf16 v[120:123], v[136:139], v[160:163], v[120:123]
    v_mfma_f32_16x16x32_bf16 v[116:119], v[136:139], v[156:159], v[116:119]
    v_mfma_f32_16x16x32_bf16 v[112:115], v[136:139], v[152:155], v[112:115]
    v_mfma_f32_16x16x32_bf16 v[108:111], v[136:139], v[148:151], v[108:111]
    v_mfma_f32_16x16x32_bf16 v[104:107], v[136:139], v[144:147], v[104:107]
    ds_read_b128 v[164:167], v42 offset:2560
    s_waitcnt lgkmcnt(15)
    v_mfma_f32_16x16x32_bf16 v[124:127], v[140:143], v[160:163], v[124:127]
    v_add_u32 v41, 1024, v40
    ds_read2_b32 v[136:137], v41 offset0:0 offset1:1
    ds_read2_b32 v[138:139], v41 offset0:2 offset1:3
    v_mfma_f32_16x16x32_bf16 v[120:123], v[140:143], v[156:159], v[120:123]
    v_mfma_f32_16x16x32_bf16 v[116:119], v[140:143], v[152:155], v[116:119]
    v_mfma_f32_16x16x32_bf16 v[112:115], v[140:143], v[148:151], v[112:115]
    v_mfma_f32_16x16x32_bf16 v[108:111], v[140:143], v[144:147], v[108:111]
    ds_read_b128 v[160:163], v42 offset:2048
    s_waitcnt lgkmcnt(15)
    v_mfma_f32_16x16x32_bf16 v[124:127], v[176:179], v[156:159], v[124:127]
    v_add_u32 v41, 1536, v40
    ds_read2_b32 v[140:141], v41 offset0:0 offset1:1
    ds_read2_b32 v[142:143], v41 offset0:2 offset1:3
    v_mfma_f32_16x16x32_bf16 v[120:123], v[176:179], v[152:155], v[120:123]
    v_mfma_f32_16x16x32_bf16 v[116:119], v[176:179], v[148:151], v[116:119]
    v_mfma_f32_16x16x32_bf16 v[112:115], v[176:179], v[144:147], v[112:115]
    ds_read_b128 v[156:159], v42 offset:1536
    s_waitcnt lgkmcnt(15)
    v_mfma_f32_16x16x32_bf16 v[124:127], v[180:183], v[152:155], v[124:127]
    v_add_u32 v41, 2048, v40
    ds_read2_b32 v[176:177], v41 offset0:0 offset1:1
    ds_read2_b32 v[178:179], v41 offset0:2 offset1:3
    v_mfma_f32_16x16x32_bf16 v[120:123], v[180:183], v[148:151], v[120:123]
    v_mfma_f32_16x16x32_bf16 v[116:119], v[180:183], v[144:147], v[116:119]
    ds_read_b128 v[152:155], v42 offset:1024
    v_mfma_f32_16x16x32_bf16 v[124:127], v[48:51], v[148:151], v[124:127]
    v_add_u32 v41, 2560, v40
    ds_read2_b32 v[180:181], v41 offset0:0 offset1:1
    ds_read2_b32 v[182:183], v41 offset0:2 offset1:3
    v_mfma_f32_16x16x32_bf16 v[120:123], v[48:51], v[144:147], v[120:123]
    ds_read_b128 v[148:151], v42 offset:512
    s_waitcnt lgkmcnt(15)
    v_mfma_f32_16x16x32_bf16 v[124:127], v[52:55], v[144:147], v[124:127]
    v_add_u32 v41, 3072, v40
    ds_read2_b32 v[48:49], v41 offset0:0 offset1:1
    ds_read2_b32 v[50:51], v41 offset0:2 offset1:3
    ds_read_b128 v[144:147], v42 offset:0
    v_add_u32 v41, 3584, v40
    ds_read2_b32 v[52:53], v41 offset0:0 offset1:1
    ds_read2_b32 v[54:55], v41 offset0:2 offset1:3
    v_add_u32 v40, 64, v40
    v_subrev_u32 v42, 64, v42
    v_mfma_f32_16x16x32_bf16 v[124:127], v[128:131], v[172:175], v[124:127]
    v_mfma_f32_16x16x32_bf16 v[120:123], v[128:131], v[168:171], v[120:123]
    s_waitcnt lgkmcnt(15)
    v_mfma_f32_16x16x32_bf16 v[116:119], v[128:131], v[164:167], v[116:119]
    s_waitcnt lgkmcnt(14)
    v_mfma_f32_16x16x32_bf16 v[112:115], v[128:131], v[160:163], v[112:115]
    s_waitcnt lgkmcnt(11)
    v_mfma_f32_16x16x32_bf16 v[108:111], v[128:131], v[156:159], v[108:111]
    s_waitcnt lgkmcnt(8)
    v_mfma_f32_16x16x32_bf16 v[104:107], v[128:131], v[152:155], v[104:107]
    s_waitcnt lgkmcnt(5)
    v_mfma_f32_16x16x32_bf16 v[100:103], v[128:131], v[148:151], v[100:103]
    s_waitcnt lgkmcnt(2)
    v_mfma_f32_16x16x32_bf16 v[96:99], v[128:131], v[144:147], v[96:99]
    ds_read_b128 v[172:175], v42 offset:3584
    v_mfma_f32_16x16x32_bf16 v[124:127], v[132:135], v[168:171], v[124:127]
    ds_read2_b32 v[128:129], v40 offset0:0 offset1:1
    ds_read2_b32 v[130:131], v40 offset0:2 offset1:3
    v_mfma_f32_16x16x32_bf16 v[120:123], v[132:135], v[164:167], v[120:123]
    v_mfma_f32_16x16x32_bf16 v[116:119], v[132:135], v[160:163], v[116:119]
    v_mfma_f32_16x16x32_bf16 v[112:115], v[132:135], v[156:159], v[112:115]
    v_mfma_f32_16x16x32_bf16 v[108:111], v[132:135], v[152:155], v[108:111]
    v_mfma_f32_16x16x32_bf16 v[104:107], v[132:135], v[148:151], v[104:107]
    v_mfma_f32_16x16x32_bf16 v[100:103], v[132:135], v[144:147], v[100:103]
    ds_read_b128 v[168:171], v42 offset:3072
    v_mfma_f32_16x16x32_bf16 v[124:127], v[136:139], v[164:167], v[124:127]
    v_add_u32 v41, 512, v40
    ds_read2_b32 v[132:133], v41 offset0:0 offset1:1
    ds_read2_b32 v[134:135], v41 offset0:2 offset1:3
    v_mfma_f32_16x16x32_bf16 v[120:123], v[136:139], v[160:163], v[120:123]
    v_mfma_f32_16x16x32_bf16 v[116:119], v[136:139], v[156:159], v[116:119]
    v_mfma_f32_16x16x32_bf16 v[112:115], v[136:139], v[152:155], v[112:115]
    v_mfma_f32_16x16x32_bf16 v[108:111], v[136:139], v[148:151], v[108:111]
    v_mfma_f32_16x16x32_bf16 v[104:107], v[136:139], v[144:147], v[104:107]
    ds_read_b128 v[164:167], v42 offset:2560
    v_mfma_f32_16x16x32_bf16 v[124:127], v[140:143], v[160:163], v[124:127]
    v_add_u32 v41, 1024, v40
    ds_read2_b32 v[136:137], v41 offset0:0 offset1:1
    ds_read2_b32 v[138:139], v41 offset0:2 offset1:3
    v_mfma_f32_16x16x32_bf16 v[120:123], v[140:143], v[156:159], v[120:123]
    v_mfma_f32_16x16x32_bf16 v[116:119], v[140:143], v[152:155], v[116:119]
    v_mfma_f32_16x16x32_bf16 v[112:115], v[140:143], v[148:151], v[112:115]
    v_mfma_f32_16x16x32_bf16 v[108:111], v[140:143], v[144:147], v[108:111]
    ds_read_b128 v[160:163], v42 offset:2048
    v_mfma_f32_16x16x32_bf16 v[124:127], v[176:179], v[156:159], v[124:127]
    v_add_u32 v41, 1536, v40
    ds_read2_b32 v[140:141], v41 offset0:0 offset1:1
    ds_read2_b32 v[142:143], v41 offset0:2 offset1:3
    v_mfma_f32_16x16x32_bf16 v[120:123], v[176:179], v[152:155], v[120:123]
    v_mfma_f32_16x16x32_bf16 v[116:119], v[176:179], v[148:151], v[116:119]
    v_mfma_f32_16x16x32_bf16 v[112:115], v[176:179], v[144:147], v[112:115]
    ds_read_b128 v[156:159], v42 offset:1536
    v_mfma_f32_16x16x32_bf16 v[124:127], v[180:183], v[152:155], v[124:127]
    v_add_u32 v41, 2048, v40
    ds_read2_b32 v[176:177], v41 offset0:0 offset1:1
    ds_read2_b32 v[178:179], v41 offset0:2 offset1:3
    v_mfma_f32_16x16x32_bf16 v[120:123], v[180:183], v[148:151], v[120:123]
    v_mfma_f32_16x16x32_bf16 v[116:119], v[180:183], v[144:147], v[116:119]
    ds_read_b128 v[152:155], v42 offset:1024
    v_mfma_f32_16x16x32_bf16 v[124:127], v[48:51], v[148:151], v[124:127]
    v_add_u32 v41, 2560, v40
    ds_read2_b32 v[180:181], v41 offset0:0 offset1:1
    ds_read2_b32 v[182:183], v41 offset0:2 offset1:3
    v_mfma_f32_16x16x32_bf16 v[120:123], v[48:51], v[144:147], v[120:123]
    ds_read_b128 v[148:151], v42 offset:512
    s_waitcnt lgkmcnt(15)
    v_mfma_f32_16x16x32_bf16 v[124:127], v[52:55], v[144:147], v[124:127]
    v_add_u32 v41, 3072, v40
    ds_read2_b32 v[48:49], v41 offset0:0 offset1:1
    ds_read2_b32 v[50:51], v41 offset0:2 offset1:3
    ds_read_b128 v[144:147], v42 offset:0
    v_add_u32 v41, 3584, v40
    ds_read2_b32 v[52:53], v41 offset0:0 offset1:1
    ds_read2_b32 v[54:55], v41 offset0:2 offset1:3
    v_add_u32 v40, 64, v40
    v_subrev_u32 v42, 64, v42
    v_mfma_f32_16x16x32_bf16 v[124:127], v[128:131], v[172:175], v[124:127]
    v_mfma_f32_16x16x32_bf16 v[120:123], v[128:131], v[168:171], v[120:123]
    s_waitcnt lgkmcnt(15)
    v_mfma_f32_16x16x32_bf16 v[116:119], v[128:131], v[164:167], v[116:119]
    s_waitcnt lgkmcnt(14)
    v_mfma_f32_16x16x32_bf16 v[112:115], v[128:131], v[160:163], v[112:115]
    s_waitcnt lgkmcnt(11)
    v_mfma_f32_16x16x32_bf16 v[108:111], v[128:131], v[156:159], v[108:111]
    s_waitcnt lgkmcnt(8)
    v_mfma_f32_16x16x32_bf16 v[104:107], v[128:131], v[152:155], v[104:107]
    s_waitcnt lgkmcnt(5)
    v_mfma_f32_16x16x32_bf16 v[100:103], v[128:131], v[148:151], v[100:103]
    s_waitcnt lgkmcnt(2)
    v_mfma_f32_16x16x32_bf16 v[96:99], v[128:131], v[144:147], v[96:99]
    ds_read_b128 v[172:175], v42 offset:3584
    v_mfma_f32_16x16x32_bf16 v[124:127], v[132:135], v[168:171], v[124:127]
    ds_read2_b32 v[128:129], v40 offset0:0 offset1:1
    ds_read2_b32 v[130:131], v40 offset0:2 offset1:3
    v_mfma_f32_16x16x32_bf16 v[120:123], v[132:135], v[164:167], v[120:123]
    v_mfma_f32_16x16x32_bf16 v[116:119], v[132:135], v[160:163], v[116:119]
    v_mfma_f32_16x16x32_bf16 v[112:115], v[132:135], v[156:159], v[112:115]
    v_mfma_f32_16x16x32_bf16 v[108:111], v[132:135], v[152:155], v[108:111]
    v_mfma_f32_16x16x32_bf16 v[104:107], v[132:135], v[148:151], v[104:107]
    v_mfma_f32_16x16x32_bf16 v[100:103], v[132:135], v[144:147], v[100:103]
    ds_read_b128 v[168:171], v42 offset:3072
    v_mfma_f32_16x16x32_bf16 v[124:127], v[136:139], v[164:167], v[124:127]
    v_add_u32 v41, 512, v40
    ds_read2_b32 v[132:133], v41 offset0:0 offset1:1
    ds_read2_b32 v[134:135], v41 offset0:2 offset1:3
    v_mfma_f32_16x16x32_bf16 v[120:123], v[136:139], v[160:163], v[120:123]
    v_mfma_f32_16x16x32_bf16 v[116:119], v[136:139], v[156:159], v[116:119]
    v_mfma_f32_16x16x32_bf16 v[112:115], v[136:139], v[152:155], v[112:115]
    v_mfma_f32_16x16x32_bf16 v[108:111], v[136:139], v[148:151], v[108:111]
    v_mfma_f32_16x16x32_bf16 v[104:107], v[136:139], v[144:147], v[104:107]
    ds_read_b128 v[164:167], v42 offset:2560
    v_mfma_f32_16x16x32_bf16 v[124:127], v[140:143], v[160:163], v[124:127]
    v_add_u32 v41, 1024, v40
    ds_read2_b32 v[136:137], v41 offset0:0 offset1:1
    ds_read2_b32 v[138:139], v41 offset0:2 offset1:3
    v_mfma_f32_16x16x32_bf16 v[120:123], v[140:143], v[156:159], v[120:123]
    v_mfma_f32_16x16x32_bf16 v[116:119], v[140:143], v[152:155], v[116:119]
    v_mfma_f32_16x16x32_bf16 v[112:115], v[140:143], v[148:151], v[112:115]
    v_mfma_f32_16x16x32_bf16 v[108:111], v[140:143], v[144:147], v[108:111]
    ds_read_b128 v[160:163], v42 offset:2048
    v_mfma_f32_16x16x32_bf16 v[124:127], v[176:179], v[156:159], v[124:127]
    v_add_u32 v41, 1536, v40
    ds_read2_b32 v[140:141], v41 offset0:0 offset1:1
    ds_read2_b32 v[142:143], v41 offset0:2 offset1:3
    v_mfma_f32_16x16x32_bf16 v[120:123], v[176:179], v[152:155], v[120:123]
    v_mfma_f32_16x16x32_bf16 v[116:119], v[176:179], v[148:151], v[116:119]
    v_mfma_f32_16x16x32_bf16 v[112:115], v[176:179], v[144:147], v[112:115]
    ds_read_b128 v[156:159], v42 offset:1536
    v_mfma_f32_16x16x32_bf16 v[124:127], v[180:183], v[152:155], v[124:127]
    v_add_u32 v41, 2048, v40
    ds_read2_b32 v[176:177], v41 offset0:0 offset1:1
    ds_read2_b32 v[178:179], v41 offset0:2 offset1:3
    v_mfma_f32_16x16x32_bf16 v[120:123], v[180:183], v[148:151], v[120:123]
    v_mfma_f32_16x16x32_bf16 v[116:119], v[180:183], v[144:147], v[116:119]
    ds_read_b128 v[152:155], v42 offset:1024
    v_mfma_f32_16x16x32_bf16 v[124:127], v[48:51], v[148:151], v[124:127]
    v_add_u32 v41, 2560, v40
    ds_read2_b32 v[180:181], v41 offset0:0 offset1:1
    ds_read2_b32 v[182:183], v41 offset0:2 offset1:3
    v_mfma_f32_16x16x32_bf16 v[120:123], v[48:51], v[144:147], v[120:123]
    ds_read_b128 v[148:151], v42 offset:512
    s_waitcnt lgkmcnt(15)
    v_mfma_f32_16x16x32_bf16 v[124:127], v[52:55], v[144:147], v[124:127]
    v_add_u32 v41, 3072, v40
    ds_read2_b32 v[48:49], v41 offset0:0 offset1:1
    ds_read2_b32 v[50:51], v41 offset0:2 offset1:3
    ds_read_b128 v[144:147], v42 offset:0
    v_add_u32 v41, 3584, v40
    ds_read2_b32 v[52:53], v41 offset0:0 offset1:1
    ds_read2_b32 v[54:55], v41 offset0:2 offset1:3
    v_add_u32 v40, 64, v40
    v_subrev_u32 v42, 64, v42
    v_mfma_f32_16x16x32_bf16 v[124:127], v[128:131], v[172:175], v[124:127]
    v_mfma_f32_16x16x32_bf16 v[120:123], v[128:131], v[168:171], v[120:123]
    s_waitcnt lgkmcnt(15)
    v_mfma_f32_16x16x32_bf16 v[116:119], v[128:131], v[164:167], v[116:119]
    s_waitcnt lgkmcnt(14)
    v_mfma_f32_16x16x32_bf16 v[112:115], v[128:131], v[160:163], v[112:115]
    s_waitcnt lgkmcnt(11)
    v_mfma_f32_16x16x32_bf16 v[108:111], v[128:131], v[156:159], v[108:111]
    s_waitcnt lgkmcnt(8)
    v_mfma_f32_16x16x32_bf16 v[104:107], v[128:131], v[152:155], v[104:107]
    s_waitcnt lgkmcnt(5)
    v_mfma_f32_16x16x32_bf16 v[100:103], v[128:131], v[148:151], v[100:103]
    s_waitcnt lgkmcnt(2)
    v_mfma_f32_16x16x32_bf16 v[96:99], v[128:131], v[144:147], v[96:99]
    ds_read_b128 v[172:175], v42 offset:3584
    v_mfma_f32_16x16x32_bf16 v[124:127], v[132:135], v[168:171], v[124:127]
    ds_read2_b32 v[128:129], v40 offset0:0 offset1:1
    ds_read2_b32 v[130:131], v40 offset0:2 offset1:3
    v_mfma_f32_16x16x32_bf16 v[120:123], v[132:135], v[164:167], v[120:123]
    v_mfma_f32_16x16x32_bf16 v[116:119], v[132:135], v[160:163], v[116:119]
    v_mfma_f32_16x16x32_bf16 v[112:115], v[132:135], v[156:159], v[112:115]
    v_mfma_f32_16x16x32_bf16 v[108:111], v[132:135], v[152:155], v[108:111]
    v_mfma_f32_16x16x32_bf16 v[104:107], v[132:135], v[148:151], v[104:107]
    v_mfma_f32_16x16x32_bf16 v[100:103], v[132:135], v[144:147], v[100:103]
    ds_read_b128 v[168:171], v42 offset:3072
    v_mfma_f32_16x16x32_bf16 v[124:127], v[136:139], v[164:167], v[124:127]
    v_add_u32 v41, 512, v40
    ds_read2_b32 v[132:133], v41 offset0:0 offset1:1
    ds_read2_b32 v[134:135], v41 offset0:2 offset1:3
    v_mfma_f32_16x16x32_bf16 v[120:123], v[136:139], v[160:163], v[120:123]
    v_mfma_f32_16x16x32_bf16 v[116:119], v[136:139], v[156:159], v[116:119]
    v_mfma_f32_16x16x32_bf16 v[112:115], v[136:139], v[152:155], v[112:115]
    v_mfma_f32_16x16x32_bf16 v[108:111], v[136:139], v[148:151], v[108:111]
    v_mfma_f32_16x16x32_bf16 v[104:107], v[136:139], v[144:147], v[104:107]
    ds_read_b128 v[164:167], v42 offset:2560
    v_mfma_f32_16x16x32_bf16 v[124:127], v[140:143], v[160:163], v[124:127]
    v_add_u32 v41, 1024, v40
    ds_read2_b32 v[136:137], v41 offset0:0 offset1:1
    ds_read2_b32 v[138:139], v41 offset0:2 offset1:3
    v_mfma_f32_16x16x32_bf16 v[120:123], v[140:143], v[156:159], v[120:123]
    v_mfma_f32_16x16x32_bf16 v[116:119], v[140:143], v[152:155], v[116:119]
    v_mfma_f32_16x16x32_bf16 v[112:115], v[140:143], v[148:151], v[112:115]
    v_mfma_f32_16x16x32_bf16 v[108:111], v[140:143], v[144:147], v[108:111]
    ds_read_b128 v[160:163], v42 offset:2048
    v_mfma_f32_16x16x32_bf16 v[124:127], v[176:179], v[156:159], v[124:127]
    v_add_u32 v41, 1536, v40
    ds_read2_b32 v[140:141], v41 offset0:0 offset1:1
    ds_read2_b32 v[142:143], v41 offset0:2 offset1:3
    v_mfma_f32_16x16x32_bf16 v[120:123], v[176:179], v[152:155], v[120:123]
    v_mfma_f32_16x16x32_bf16 v[116:119], v[176:179], v[148:151], v[116:119]
    v_mfma_f32_16x16x32_bf16 v[112:115], v[176:179], v[144:147], v[112:115]
    ds_read_b128 v[156:159], v42 offset:1536
    v_mfma_f32_16x16x32_bf16 v[124:127], v[180:183], v[152:155], v[124:127]
    v_add_u32 v41, 2048, v40
    ds_read2_b32 v[176:177], v41 offset0:0 offset1:1
    ds_read2_b32 v[178:179], v41 offset0:2 offset1:3
    v_mfma_f32_16x16x32_bf16 v[120:123], v[180:183], v[148:151], v[120:123]
    v_mfma_f32_16x16x32_bf16 v[116:119], v[180:183], v[144:147], v[116:119]
    ds_read_b128 v[152:155], v42 offset:1024
    v_mfma_f32_16x16x32_bf16 v[124:127], v[48:51], v[148:151], v[124:127]
    v_add_u32 v41, 2560, v40
    ds_read2_b32 v[180:181], v41 offset0:0 offset1:1
    ds_read2_b32 v[182:183], v41 offset0:2 offset1:3
    v_mfma_f32_16x16x32_bf16 v[120:123], v[48:51], v[144:147], v[120:123]
    ds_read_b128 v[148:151], v42 offset:512
    s_waitcnt lgkmcnt(15)
    v_mfma_f32_16x16x32_bf16 v[124:127], v[52:55], v[144:147], v[124:127]
    v_add_u32 v41, 3072, v40
    ds_read2_b32 v[48:49], v41 offset0:0 offset1:1
    ds_read2_b32 v[50:51], v41 offset0:2 offset1:3
    ds_read_b128 v[144:147], v42 offset:0
    v_add_u32 v41, 3584, v40
    ds_read2_b32 v[52:53], v41 offset0:0 offset1:1
    ds_read2_b32 v[54:55], v41 offset0:2 offset1:3
    v_add_u32 v40, 64, v40
    v_subrev_u32 v42, 64, v42
    v_mfma_f32_16x16x32_bf16 v[124:127], v[128:131], v[172:175], v[124:127]
    v_mfma_f32_16x16x32_bf16 v[120:123], v[128:131], v[168:171], v[120:123]
    s_waitcnt lgkmcnt(15)
    v_mfma_f32_16x16x32_bf16 v[116:119], v[128:131], v[164:167], v[116:119]
    s_waitcnt lgkmcnt(14)
    v_mfma_f32_16x16x32_bf16 v[112:115], v[128:131], v[160:163], v[112:115]
    s_waitcnt lgkmcnt(11)
    v_mfma_f32_16x16x32_bf16 v[108:111], v[128:131], v[156:159], v[108:111]
    s_waitcnt lgkmcnt(8)
    v_mfma_f32_16x16x32_bf16 v[104:107], v[128:131], v[152:155], v[104:107]
    s_waitcnt lgkmcnt(5)
    v_mfma_f32_16x16x32_bf16 v[100:103], v[128:131], v[148:151], v[100:103]
    s_waitcnt lgkmcnt(2)
    v_mfma_f32_16x16x32_bf16 v[96:99], v[128:131], v[144:147], v[96:99]
    ds_read_b128 v[172:175], v42 offset:3584
    v_mfma_f32_16x16x32_bf16 v[124:127], v[132:135], v[168:171], v[124:127]
    ds_read2_b32 v[128:129], v40 offset0:0 offset1:1
    ds_read2_b32 v[130:131], v40 offset0:2 offset1:3
    v_mfma_f32_16x16x32_bf16 v[120:123], v[132:135], v[164:167], v[120:123]
    v_mfma_f32_16x16x32_bf16 v[116:119], v[132:135], v[160:163], v[116:119]
    v_mfma_f32_16x16x32_bf16 v[112:115], v[132:135], v[156:159], v[112:115]
    v_mfma_f32_16x16x32_bf16 v[108:111], v[132:135], v[152:155], v[108:111]
    v_mfma_f32_16x16x32_bf16 v[104:107], v[132:135], v[148:151], v[104:107]
    v_mfma_f32_16x16x32_bf16 v[100:103], v[132:135], v[144:147], v[100:103]
    ds_read_b128 v[168:171], v42 offset:3072
    v_mfma_f32_16x16x32_bf16 v[124:127], v[136:139], v[164:167], v[124:127]
    v_add_u32 v41, 512, v40
    ds_read2_b32 v[132:133], v41 offset0:0 offset1:1
    ds_read2_b32 v[134:135], v41 offset0:2 offset1:3
    v_mfma_f32_16x16x32_bf16 v[120:123], v[136:139], v[160:163], v[120:123]
    v_mfma_f32_16x16x32_bf16 v[116:119], v[136:139], v[156:159], v[116:119]
    v_mfma_f32_16x16x32_bf16 v[112:115], v[136:139], v[152:155], v[112:115]
    v_mfma_f32_16x16x32_bf16 v[108:111], v[136:139], v[148:151], v[108:111]
    v_mfma_f32_16x16x32_bf16 v[104:107], v[136:139], v[144:147], v[104:107]
    ds_read_b128 v[164:167], v42 offset:2560
    v_mfma_f32_16x16x32_bf16 v[124:127], v[140:143], v[160:163], v[124:127]
    v_add_u32 v41, 1024, v40
    ds_read2_b32 v[136:137], v41 offset0:0 offset1:1
    ds_read2_b32 v[138:139], v41 offset0:2 offset1:3
    v_mfma_f32_16x16x32_bf16 v[120:123], v[140:143], v[156:159], v[120:123]
    v_mfma_f32_16x16x32_bf16 v[116:119], v[140:143], v[152:155], v[116:119]
    v_mfma_f32_16x16x32_bf16 v[112:115], v[140:143], v[148:151], v[112:115]
    v_mfma_f32_16x16x32_bf16 v[108:111], v[140:143], v[144:147], v[108:111]
    ds_read_b128 v[160:163], v42 offset:2048
    v_mfma_f32_16x16x32_bf16 v[124:127], v[176:179], v[156:159], v[124:127]
    v_add_u32 v41, 1536, v40
    ds_read2_b32 v[140:141], v41 offset0:0 offset1:1
    ds_read2_b32 v[142:143], v41 offset0:2 offset1:3
    v_mfma_f32_16x16x32_bf16 v[120:123], v[176:179], v[152:155], v[120:123]
    v_mfma_f32_16x16x32_bf16 v[116:119], v[176:179], v[148:151], v[116:119]
    v_mfma_f32_16x16x32_bf16 v[112:115], v[176:179], v[144:147], v[112:115]
    ds_read_b128 v[156:159], v42 offset:1536
    v_mfma_f32_16x16x32_bf16 v[124:127], v[180:183], v[152:155], v[124:127]
    v_add_u32 v41, 2048, v40
    ds_read2_b32 v[176:177], v41 offset0:0 offset1:1
    ds_read2_b32 v[178:179], v41 offset0:2 offset1:3
    v_mfma_f32_16x16x32_bf16 v[120:123], v[180:183], v[148:151], v[120:123]
    v_mfma_f32_16x16x32_bf16 v[116:119], v[180:183], v[144:147], v[116:119]
    ds_read_b128 v[152:155], v42 offset:1024
    v_mfma_f32_16x16x32_bf16 v[124:127], v[48:51], v[148:151], v[124:127]
    v_add_u32 v41, 2560, v40
    ds_read2_b32 v[180:181], v41 offset0:0 offset1:1
    ds_read2_b32 v[182:183], v41 offset0:2 offset1:3
    v_mfma_f32_16x16x32_bf16 v[120:123], v[48:51], v[144:147], v[120:123]
    ds_read_b128 v[148:151], v42 offset:512
    s_waitcnt lgkmcnt(15)
    v_mfma_f32_16x16x32_bf16 v[124:127], v[52:55], v[144:147], v[124:127]
    v_add_u32 v41, 3072, v40
    ds_read2_b32 v[48:49], v41 offset0:0 offset1:1
    ds_read2_b32 v[50:51], v41 offset0:2 offset1:3
    ds_read_b128 v[144:147], v42 offset:0
    v_add_u32 v41, 3584, v40
    ds_read2_b32 v[52:53], v41 offset0:0 offset1:1
    ds_read2_b32 v[54:55], v41 offset0:2 offset1:3
    v_add_u32 v40, 64, v40
    v_subrev_u32 v42, 64, v42
    v_mfma_f32_16x16x32_bf16 v[124:127], v[128:131], v[172:175], v[124:127]
    v_mfma_f32_16x16x32_bf16 v[120:123], v[128:131], v[168:171], v[120:123]
    s_waitcnt lgkmcnt(15)
    v_mfma_f32_16x16x32_bf16 v[116:119], v[128:131], v[164:167], v[116:119]
    s_waitcnt lgkmcnt(14)
    v_mfma_f32_16x16x32_bf16 v[112:115], v[128:131], v[160:163], v[112:115]
    s_waitcnt lgkmcnt(11)
    v_mfma_f32_16x16x32_bf16 v[108:111], v[128:131], v[156:159], v[108:111]
    s_waitcnt lgkmcnt(8)
    v_mfma_f32_16x16x32_bf16 v[104:107], v[128:131], v[152:155], v[104:107]
    s_waitcnt lgkmcnt(5)
    v_mfma_f32_16x16x32_bf16 v[100:103], v[128:131], v[148:151], v[100:103]
    s_waitcnt lgkmcnt(2)
    v_mfma_f32_16x16x32_bf16 v[96:99], v[128:131], v[144:147], v[96:99]
    ds_read_b128 v[172:175], v42 offset:3584
    v_mfma_f32_16x16x32_bf16 v[124:127], v[132:135], v[168:171], v[124:127]
    ds_read2_b32 v[128:129], v40 offset0:0 offset1:1
    ds_read2_b32 v[130:131], v40 offset0:2 offset1:3
    v_mfma_f32_16x16x32_bf16 v[120:123], v[132:135], v[164:167], v[120:123]
    v_mfma_f32_16x16x32_bf16 v[116:119], v[132:135], v[160:163], v[116:119]
    v_mfma_f32_16x16x32_bf16 v[112:115], v[132:135], v[156:159], v[112:115]
    v_mfma_f32_16x16x32_bf16 v[108:111], v[132:135], v[152:155], v[108:111]
    v_mfma_f32_16x16x32_bf16 v[104:107], v[132:135], v[148:151], v[104:107]
    v_mfma_f32_16x16x32_bf16 v[100:103], v[132:135], v[144:147], v[100:103]
    ds_read_b128 v[168:171], v42 offset:3072
    v_mfma_f32_16x16x32_bf16 v[124:127], v[136:139], v[164:167], v[124:127]
    v_add_u32 v41, 512, v40
    ds_read2_b32 v[132:133], v41 offset0:0 offset1:1
    ds_read2_b32 v[134:135], v41 offset0:2 offset1:3
    v_mfma_f32_16x16x32_bf16 v[120:123], v[136:139], v[160:163], v[120:123]
    v_mfma_f32_16x16x32_bf16 v[116:119], v[136:139], v[156:159], v[116:119]
    v_mfma_f32_16x16x32_bf16 v[112:115], v[136:139], v[152:155], v[112:115]
    v_mfma_f32_16x16x32_bf16 v[108:111], v[136:139], v[148:151], v[108:111]
    v_mfma_f32_16x16x32_bf16 v[104:107], v[136:139], v[144:147], v[104:107]
    ds_read_b128 v[164:167], v42 offset:2560
    v_mfma_f32_16x16x32_bf16 v[124:127], v[140:143], v[160:163], v[124:127]
    v_add_u32 v41, 1024, v40
    ds_read2_b32 v[136:137], v41 offset0:0 offset1:1
    ds_read2_b32 v[138:139], v41 offset0:2 offset1:3
    v_mfma_f32_16x16x32_bf16 v[120:123], v[140:143], v[156:159], v[120:123]
    v_mfma_f32_16x16x32_bf16 v[116:119], v[140:143], v[152:155], v[116:119]
    v_mfma_f32_16x16x32_bf16 v[112:115], v[140:143], v[148:151], v[112:115]
    v_mfma_f32_16x16x32_bf16 v[108:111], v[140:143], v[144:147], v[108:111]
    ds_read_b128 v[160:163], v42 offset:2048
    v_mfma_f32_16x16x32_bf16 v[124:127], v[176:179], v[156:159], v[124:127]
    v_add_u32 v41, 1536, v40
    ds_read2_b32 v[140:141], v41 offset0:0 offset1:1
    ds_read2_b32 v[142:143], v41 offset0:2 offset1:3
    v_mfma_f32_16x16x32_bf16 v[120:123], v[176:179], v[152:155], v[120:123]
    v_mfma_f32_16x16x32_bf16 v[116:119], v[176:179], v[148:151], v[116:119]
    v_mfma_f32_16x16x32_bf16 v[112:115], v[176:179], v[144:147], v[112:115]
    ds_read_b128 v[156:159], v42 offset:1536
    v_mfma_f32_16x16x32_bf16 v[124:127], v[180:183], v[152:155], v[124:127]
    v_add_u32 v41, 2048, v40
    ds_read2_b32 v[176:177], v41 offset0:0 offset1:1
    ds_read2_b32 v[178:179], v41 offset0:2 offset1:3
    v_mfma_f32_16x16x32_bf16 v[120:123], v[180:183], v[148:151], v[120:123]
    v_mfma_f32_16x16x32_bf16 v[116:119], v[180:183], v[144:147], v[116:119]
    ds_read_b128 v[152:155], v42 offset:1024
    v_mfma_f32_16x16x32_bf16 v[124:127], v[48:51], v[148:151], v[124:127]
    v_add_u32 v41, 2560, v40
    ds_read2_b32 v[180:181], v41 offset0:0 offset1:1
    ds_read2_b32 v[182:183], v41 offset0:2 offset1:3
    v_mfma_f32_16x16x32_bf16 v[120:123], v[48:51], v[144:147], v[120:123]
    ds_read_b128 v[148:151], v42 offset:512
    s_waitcnt lgkmcnt(15)
    v_mfma_f32_16x16x32_bf16 v[124:127], v[52:55], v[144:147], v[124:127]
    v_add_u32 v41, 3072, v40
    ds_read2_b32 v[48:49], v41 offset0:0 offset1:1
    ds_read2_b32 v[50:51], v41 offset0:2 offset1:3
    ds_read_b128 v[144:147], v42 offset:0
    v_add_u32 v41, 3584, v40
    ds_read2_b32 v[52:53], v41 offset0:0 offset1:1
    ds_read2_b32 v[54:55], v41 offset0:2 offset1:3
    v_add_u32 v40, 64, v40
    v_subrev_u32 v42, 64, v42
    v_and_b32 v46, 15, v1
    v_lshrrev_b32 v47, 4, v1
    v_lshlrev_b32 v59, 5, v46
    v_lshrrev_b32 v60, 1, v47
    v_lshl_add_u32 v59, v60, 4, v59
    v_and_b32 v60, 1, v47
    v_xor_b32 v60, 1, v60
    v_lshl_add_u32 v59, v60, 3, v59
    v_add_u32 v59, 8832, v59
    v_add_u32 v59, s94, v59
    v_lshlrev_b32 v60, 5, v46
    v_lshl_add_u32 v60, v47, 3, v60
    v_mov_b32 v61, s79
    s_lshl_b32 s80, s84, 12
    s_add_u32 s80, s80, 655360
    v_mfma_f32_16x16x32_bf16 v[124:127], v[128:131], v[172:175], v[124:127]
    v_mfma_f32_16x16x32_bf16 v[120:123], v[128:131], v[168:171], v[120:123]
    s_waitcnt lgkmcnt(15)
    v_mfma_f32_16x16x32_bf16 v[116:119], v[128:131], v[164:167], v[116:119]
    s_waitcnt lgkmcnt(14)
    v_mfma_f32_16x16x32_bf16 v[112:115], v[128:131], v[160:163], v[112:115]
    s_waitcnt lgkmcnt(11)
    v_mfma_f32_16x16x32_bf16 v[108:111], v[128:131], v[156:159], v[108:111]
    s_waitcnt lgkmcnt(8)
    v_mfma_f32_16x16x32_bf16 v[104:107], v[128:131], v[152:155], v[104:107]
    s_waitcnt lgkmcnt(5)
    v_mfma_f32_16x16x32_bf16 v[100:103], v[128:131], v[148:151], v[100:103]
    s_waitcnt lgkmcnt(2)
    v_mfma_f32_16x16x32_bf16 v[96:99], v[128:131], v[144:147], v[96:99]
    ds_read_b128 v[172:175], v42 offset:3584
    v_mfma_f32_16x16x32_bf16 v[124:127], v[132:135], v[168:171], v[124:127]
    ds_read2_b32 v[128:129], v40 offset0:0 offset1:1
    ds_read2_b32 v[130:131], v40 offset0:2 offset1:3
    v_mfma_f32_16x16x32_bf16 v[120:123], v[132:135], v[164:167], v[120:123]
    v_mfma_f32_16x16x32_bf16 v[116:119], v[132:135], v[160:163], v[116:119]
    v_mfma_f32_16x16x32_bf16 v[112:115], v[132:135], v[156:159], v[112:115]
    v_mfma_f32_16x16x32_bf16 v[108:111], v[132:135], v[152:155], v[108:111]
    v_mfma_f32_16x16x32_bf16 v[104:107], v[132:135], v[148:151], v[104:107]
    v_mfma_f32_16x16x32_bf16 v[100:103], v[132:135], v[144:147], v[100:103]
    ds_read_b128 v[168:171], v42 offset:3072
    v_mfma_f32_16x16x32_bf16 v[124:127], v[136:139], v[164:167], v[124:127]
    v_add_u32 v41, 512, v40
    ds_read2_b32 v[132:133], v41 offset0:0 offset1:1
    ds_read2_b32 v[134:135], v41 offset0:2 offset1:3
    v_mfma_f32_16x16x32_bf16 v[120:123], v[136:139], v[160:163], v[120:123]
    v_mfma_f32_16x16x32_bf16 v[116:119], v[136:139], v[156:159], v[116:119]
    v_mfma_f32_16x16x32_bf16 v[112:115], v[136:139], v[152:155], v[112:115]
    v_mfma_f32_16x16x32_bf16 v[108:111], v[136:139], v[148:151], v[108:111]
    v_mfma_f32_16x16x32_bf16 v[104:107], v[136:139], v[144:147], v[104:107]
    ds_read_b128 v[164:167], v42 offset:2560
    v_mfma_f32_16x16x32_bf16 v[124:127], v[140:143], v[160:163], v[124:127]
    v_add_u32 v41, 1024, v40
    ds_read2_b32 v[136:137], v41 offset0:0 offset1:1
    ds_read2_b32 v[138:139], v41 offset0:2 offset1:3
    v_mfma_f32_16x16x32_bf16 v[120:123], v[140:143], v[156:159], v[120:123]
    v_mfma_f32_16x16x32_bf16 v[116:119], v[140:143], v[152:155], v[116:119]
    v_mfma_f32_16x16x32_bf16 v[112:115], v[140:143], v[148:151], v[112:115]
    v_mfma_f32_16x16x32_bf16 v[108:111], v[140:143], v[144:147], v[108:111]
    ds_read_b128 v[160:163], v42 offset:2048
    v_mfma_f32_16x16x32_bf16 v[124:127], v[176:179], v[156:159], v[124:127]
    v_add_u32 v41, 1536, v40
    ds_read2_b32 v[140:141], v41 offset0:0 offset1:1
    ds_read2_b32 v[142:143], v41 offset0:2 offset1:3
    v_mfma_f32_16x16x32_bf16 v[120:123], v[176:179], v[152:155], v[120:123]
    v_mfma_f32_16x16x32_bf16 v[116:119], v[176:179], v[148:151], v[116:119]
    v_mfma_f32_16x16x32_bf16 v[112:115], v[176:179], v[144:147], v[112:115]
    ds_read_b128 v[156:159], v42 offset:1536
    v_mfma_f32_16x16x32_bf16 v[124:127], v[180:183], v[152:155], v[124:127]
    v_add_u32 v41, 2048, v40
    ds_read2_b32 v[176:177], v41 offset0:0 offset1:1
    ds_read2_b32 v[178:179], v41 offset0:2 offset1:3
    v_mfma_f32_16x16x32_bf16 v[120:123], v[180:183], v[148:151], v[120:123]
    v_mfma_f32_16x16x32_bf16 v[116:119], v[180:183], v[144:147], v[116:119]
    ds_read_b128 v[152:155], v42 offset:1024
    v_mfma_f32_16x16x32_bf16 v[124:127], v[48:51], v[148:151], v[124:127]
    v_add_u32 v41, 2560, v40
    ds_read2_b32 v[180:181], v41 offset0:0 offset1:1
    ds_read2_b32 v[182:183], v41 offset0:2 offset1:3
    v_mfma_f32_16x16x32_bf16 v[120:123], v[48:51], v[144:147], v[120:123]
    ds_read_b128 v[148:151], v42 offset:512
    s_waitcnt lgkmcnt(15)
    v_mfma_f32_16x16x32_bf16 v[124:127], v[52:55], v[144:147], v[124:127]
    v_add_u32 v41, 3072, v40
    ds_read2_b32 v[48:49], v41 offset0:0 offset1:1
    ds_read2_b32 v[50:51], v41 offset0:2 offset1:3
    ds_read_b128 v[144:147], v42 offset:0
    v_add_u32 v41, 3584, v40
    ds_read2_b32 v[52:53], v41 offset0:0 offset1:1
    ds_read2_b32 v[54:55], v41 offset0:2 offset1:3
    v_add_u32 v40, 64, v40
    v_subrev_u32 v42, 64, v42
    v_mfma_f32_16x16x32_bf16 v[124:127], v[128:131], v[172:175], v[124:127]
    v_mfma_f32_16x16x32_bf16 v[120:123], v[128:131], v[168:171], v[120:123]
    s_waitcnt lgkmcnt(15)
    v_mfma_f32_16x16x32_bf16 v[116:119], v[128:131], v[164:167], v[116:119]
    s_waitcnt lgkmcnt(14)
    v_mfma_f32_16x16x32_bf16 v[112:115], v[128:131], v[160:163], v[112:115]
    s_waitcnt lgkmcnt(11)
    v_mfma_f32_16x16x32_bf16 v[108:111], v[128:131], v[156:159], v[108:111]
    s_waitcnt lgkmcnt(8)
    v_mfma_f32_16x16x32_bf16 v[104:107], v[128:131], v[152:155], v[104:107]
    s_waitcnt lgkmcnt(5)
    v_mfma_f32_16x16x32_bf16 v[100:103], v[128:131], v[148:151], v[100:103]
    s_waitcnt lgkmcnt(2)
    v_mfma_f32_16x16x32_bf16 v[96:99], v[128:131], v[144:147], v[96:99]
    ds_read_b64 v[172:173], v59 offset:0
    v_mfma_f32_16x16x32_bf16 v[124:127], v[132:135], v[168:171], v[124:127]
    v_mfma_f32_16x16x32_bf16 v[120:123], v[132:135], v[164:167], v[120:123]
    v_mfma_f32_16x16x32_bf16 v[116:119], v[132:135], v[160:163], v[116:119]
    v_mfma_f32_16x16x32_bf16 v[112:115], v[132:135], v[156:159], v[112:115]
    v_mfma_f32_16x16x32_bf16 v[108:111], v[132:135], v[152:155], v[108:111]
    v_mfma_f32_16x16x32_bf16 v[104:107], v[132:135], v[148:151], v[104:107]
    v_mfma_f32_16x16x32_bf16 v[100:103], v[132:135], v[144:147], v[100:103]
    ds_read_b64 v[168:169], v59 offset:512
    s_waitcnt lgkmcnt(1)
    v_and_b32 v174, 0xffff0000, v173
    v_lshlrev_b32 v175, 16, v173
    v_pk_fma_f32 v[96:97], v[174:175], v[60:61], v[96:97] op_sel:[0,1,0] op_sel_hi:[1,1,1]
    v_and_b32 v174, 0xffff0000, v172
    v_lshlrev_b32 v175, 16, v172
    v_pk_fma_f32 v[98:99], v[174:175], v[60:61], v[98:99] op_sel:[0,1,0] op_sel_hi:[1,1,1]
    v_cvt_pk_bf16_f32 v172, v96, v97
    v_cvt_pk_bf16_f32 v173, v98, v99
    buffer_store_dwordx2 v[172:173], v60, s[4:7], s80 offen offset:0 sc1
    v_mfma_f32_16x16x32_bf16 v[124:127], v[136:139], v[164:167], v[124:127]
    v_mfma_f32_16x16x32_bf16 v[120:123], v[136:139], v[160:163], v[120:123]
    v_mfma_f32_16x16x32_bf16 v[116:119], v[136:139], v[156:159], v[116:119]
    v_mfma_f32_16x16x32_bf16 v[112:115], v[136:139], v[152:155], v[112:115]
    v_mfma_f32_16x16x32_bf16 v[108:111], v[136:139], v[148:151], v[108:111]
    v_mfma_f32_16x16x32_bf16 v[104:107], v[136:139], v[144:147], v[104:107]
    ds_read_b64 v[164:165], v59 offset:1024
    s_waitcnt lgkmcnt(1)
    v_and_b32 v170, 0xffff0000, v169
    v_lshlrev_b32 v171, 16, v169
    v_pk_fma_f32 v[100:101], v[170:171], v[60:61], v[100:101] op_sel:[0,1,0] op_sel_hi:[1,1,1]
    v_and_b32 v170, 0xffff0000, v168
    v_lshlrev_b32 v171, 16, v168
    v_pk_fma_f32 v[102:103], v[170:171], v[60:61], v[102:103] op_sel:[0,1,0] op_sel_hi:[1,1,1]
    v_cvt_pk_bf16_f32 v168, v100, v101
    v_cvt_pk_bf16_f32 v169, v102, v103
    buffer_store_dwordx2 v[168:169], v60, s[4:7], s80 offen offset:512 sc1
    v_mfma_f32_16x16x32_bf16 v[124:127], v[140:143], v[160:163], v[124:127]
    v_mfma_f32_16x16x32_bf16 v[120:123], v[140:143], v[156:159], v[120:123]
    v_mfma_f32_16x16x32_bf16 v[116:119], v[140:143], v[152:155], v[116:119]
    v_mfma_f32_16x16x32_bf16 v[112:115], v[140:143], v[148:151], v[112:115]
    v_mfma_f32_16x16x32_bf16 v[108:111], v[140:143], v[144:147], v[108:111]
    ds_read_b64 v[160:161], v59 offset:1536
    s_waitcnt lgkmcnt(1)
    v_and_b32 v166, 0xffff0000, v165
    v_lshlrev_b32 v167, 16, v165
    v_pk_fma_f32 v[104:105], v[166:167], v[60:61], v[104:105] op_sel:[0,1,0] op_sel_hi:[1,1,1]
    v_and_b32 v166, 0xffff0000, v164
    v_lshlrev_b32 v167, 16, v164
    v_pk_fma_f32 v[106:107], v[166:167], v[60:61], v[106:107] op_sel:[0,1,0] op_sel_hi:[1,1,1]
    v_cvt_pk_bf16_f32 v164, v104, v105
    v_cvt_pk_bf16_f32 v165, v106, v107
    buffer_store_dwordx2 v[164:165], v60, s[4:7], s80 offen offset:1024 sc1
    v_mfma_f32_16x16x32_bf16 v[124:127], v[176:179], v[156:159], v[124:127]
    v_mfma_f32_16x16x32_bf16 v[120:123], v[176:179], v[152:155], v[120:123]
    v_mfma_f32_16x16x32_bf16 v[116:119], v[176:179], v[148:151], v[116:119]
    v_mfma_f32_16x16x32_bf16 v[112:115], v[176:179], v[144:147], v[112:115]
    ds_read_b64 v[156:157], v59 offset:2048
    s_waitcnt lgkmcnt(1)
    v_and_b32 v162, 0xffff0000, v161
    v_lshlrev_b32 v163, 16, v161
    v_pk_fma_f32 v[108:109], v[162:163], v[60:61], v[108:109] op_sel:[0,1,0] op_sel_hi:[1,1,1]
    v_and_b32 v162, 0xffff0000, v160
    v_lshlrev_b32 v163, 16, v160
    v_pk_fma_f32 v[110:111], v[162:163], v[60:61], v[110:111] op_sel:[0,1,0] op_sel_hi:[1,1,1]
    v_cvt_pk_bf16_f32 v160, v108, v109
    v_cvt_pk_bf16_f32 v161, v110, v111
    buffer_store_dwordx2 v[160:161], v60, s[4:7], s80 offen offset:1536 sc1
    v_mfma_f32_16x16x32_bf16 v[124:127], v[180:183], v[152:155], v[124:127]
    v_mfma_f32_16x16x32_bf16 v[120:123], v[180:183], v[148:151], v[120:123]
    v_mfma_f32_16x16x32_bf16 v[116:119], v[180:183], v[144:147], v[116:119]
    ds_read_b64 v[152:153], v59 offset:2560
    s_waitcnt lgkmcnt(1)
    v_and_b32 v158, 0xffff0000, v157
    v_lshlrev_b32 v159, 16, v157
    v_pk_fma_f32 v[112:113], v[158:159], v[60:61], v[112:113] op_sel:[0,1,0] op_sel_hi:[1,1,1]
    v_and_b32 v158, 0xffff0000, v156
    v_lshlrev_b32 v159, 16, v156
    v_pk_fma_f32 v[114:115], v[158:159], v[60:61], v[114:115] op_sel:[0,1,0] op_sel_hi:[1,1,1]
    v_cvt_pk_bf16_f32 v156, v112, v113
    v_cvt_pk_bf16_f32 v157, v114, v115
    buffer_store_dwordx2 v[156:157], v60, s[4:7], s80 offen offset:2048 sc1
    v_mfma_f32_16x16x32_bf16 v[124:127], v[48:51], v[148:151], v[124:127]
    v_mfma_f32_16x16x32_bf16 v[120:123], v[48:51], v[144:147], v[120:123]
    ds_read_b64 v[148:149], v59 offset:3072
    s_waitcnt lgkmcnt(1)
    v_and_b32 v154, 0xffff0000, v153
    v_lshlrev_b32 v155, 16, v153
    v_pk_fma_f32 v[116:117], v[154:155], v[60:61], v[116:117] op_sel:[0,1,0] op_sel_hi:[1,1,1]
    v_and_b32 v154, 0xffff0000, v152
    v_lshlrev_b32 v155, 16, v152
    v_pk_fma_f32 v[118:119], v[154:155], v[60:61], v[118:119] op_sel:[0,1,0] op_sel_hi:[1,1,1]
    v_cvt_pk_bf16_f32 v152, v116, v117
    v_cvt_pk_bf16_f32 v153, v118, v119
    buffer_store_dwordx2 v[152:153], v60, s[4:7], s80 offen offset:2560 sc1
    v_mfma_f32_16x16x32_bf16 v[124:127], v[52:55], v[144:147], v[124:127]
    ds_read_b64 v[144:145], v59 offset:3584
    s_waitcnt lgkmcnt(1)
    v_and_b32 v150, 0xffff0000, v149
    v_lshlrev_b32 v151, 16, v149
    v_pk_fma_f32 v[120:121], v[150:151], v[60:61], v[120:121] op_sel:[0,1,0] op_sel_hi:[1,1,1]
    v_and_b32 v150, 0xffff0000, v148
    v_lshlrev_b32 v151, 16, v148
    v_pk_fma_f32 v[122:123], v[150:151], v[60:61], v[122:123] op_sel:[0,1,0] op_sel_hi:[1,1,1]
    v_cvt_pk_bf16_f32 v148, v120, v121
    v_cvt_pk_bf16_f32 v149, v122, v123
    buffer_store_dwordx2 v[148:149], v60, s[4:7], s80 offen offset:3072 sc1
    s_waitcnt lgkmcnt(0)
    v_and_b32 v146, 0xffff0000, v145
    v_lshlrev_b32 v147, 16, v145
    v_pk_fma_f32 v[124:125], v[146:147], v[60:61], v[124:125] op_sel:[0,1,0] op_sel_hi:[1,1,1]
    v_and_b32 v146, 0xffff0000, v144
    v_lshlrev_b32 v147, 16, v144
    v_pk_fma_f32 v[126:127], v[146:147], v[60:61], v[126:127] op_sel:[0,1,0] op_sel_hi:[1,1,1]
    v_cvt_pk_bf16_f32 v144, v124, v125
    v_cvt_pk_bf16_f32 v145, v126, v127
    buffer_store_dwordx2 v[144:145], v60, s[4:7], s80 offen offset:3584 sc1
    s_branch L_nohf
L_noconv:
    s_cmp_eq_u32 s46, 3
    s_cbranch_scc0 L_nohf
    s_cmp_eq_u32 s44, 7
    s_cbranch_scc1 Lhp_11
    s_mov_b32 s53, 0
    s_lshl_b32 s53, s53, 10
    v_add_u32 v59, s53, v22
    ds_read_b128 v[96:99], v59 offset:0
    ds_read_b128 v[100:103], v59 offset:1024
    ds_read_b128 v[104:107], v59 offset:2048
    ds_read_b128 v[108:111], v59 offset:3072
    ds_read_b128 v[112:115], v59 offset:4096
    ds_read_b128 v[116:119], v59 offset:5120
    ds_read_b128 v[120:123], v59 offset:6144
    ds_read_b128 v[124:127], v59 offset:7168
    ds_read_b128 v[128:131], v59 offset:8192
    ds_read_b128 v[132:135], v59 offset:9216
    ds_read_b128 v[136:139], v59 offset:10240
    ds_read_b128 v[140:143], v59 offset:11264
    s_lshl_b32 s52, s49, 3
    s_add_u32 s52, s52, s44
    s_lshl_b32 s52, s52, 5
    s_add_u32 s52, s52, s45
    s_mul_i32 s52, s52, 24576
    s_add_u32 s52, s52, 12582912
    s_waitcnt lgkmcnt(11)
    buffer_store_dwordx4 v[96:99], v59, s[4:7], s52 offen offset:0 sc1
    s_waitcnt lgkmcnt(10)
    buffer_store_dwordx4 v[100:103], v59, s[4:7], s52 offen offset:1024 sc1
    s_waitcnt lgkmcnt(9)
    buffer_store_dwordx4 v[104:107], v59, s[4:7], s52 offen offset:2048 sc1
    s_waitcnt lgkmcnt(8)
    buffer_store_dwordx4 v[108:111], v59, s[4:7], s52 offen offset:3072 sc1
    s_waitcnt lgkmcnt(7)
    s_add_u32 s52, s52, 4096
    buffer_store_dwordx4 v[112:115], v59, s[4:7], s52 offen offset:0 sc1
    s_waitcnt lgkmcnt(6)
    buffer_store_dwordx4 v[116:119], v59, s[4:7], s52 offen offset:1024 sc1
    s_waitcnt lgkmcnt(5)
    buffer_store_dwordx4 v[120:123], v59, s[4:7], s52 offen offset:2048 sc1
    s_waitcnt lgkmcnt(4)
    buffer_store_dwordx4 v[124:127], v59, s[4:7], s52 offen offset:3072 sc1
    s_waitcnt lgkmcnt(3)
    s_add_u32 s52, s52, 4096
    buffer_store_dwordx4 v[128:131], v59, s[4:7], s52 offen offset:0 sc1
    s_waitcnt lgkmcnt(2)
    buffer_store_dwordx4 v[132:135], v59, s[4:7], s52 offen offset:1024 sc1
    s_waitcnt lgkmcnt(1)
    buffer_store_dwordx4 v[136:139], v59, s[4:7], s52 offen offset:2048 sc1
    s_waitcnt lgkmcnt(0)
    buffer_store_dwordx4 v[140:143], v59, s[4:7], s52 offen offset:3072 sc1
Lhp_11:
    s_cmp_eq_u32 s44, 7
    s_cbranch_scc1 Lhp_12
    s_mov_b32 s53, 12
    s_lshl_b32 s53, s53, 10
    v_add_u32 v59, s53, v22
    ds_read_b128 v[96:99], v59 offset:0
    ds_read_b128 v[100:103], v59 offset:1024
    ds_read_b128 v[104:107], v59 offset:2048
    ds_read_b128 v[108:111], v59 offset:3072
    ds_read_b128 v[112:115], v59 offset:4096
    ds_read_b128 v[116:119], v59 offset:5120
    ds_read_b128 v[120:123], v59 offset:6144
    ds_read_b128 v[124:127], v59 offset:7168
    ds_read_b128 v[128:131], v59 offset:8192
    ds_read_b128 v[132:135], v59 offset:9216
    ds_read_b128 v[136:139], v59 offset:10240
    ds_read_b128 v[140:143], v59 offset:11264
    s_lshl_b32 s52, s49, 3
    s_add_u32 s52, s52, s44
    s_lshl_b32 s52, s52, 5
    s_add_u32 s52, s52, s45
    s_mul_i32 s52, s52, 24576
    s_add_u32 s52, s52, 12582912
    s_waitcnt lgkmcnt(11)
    buffer_store_dwordx4 v[96:99], v59, s[4:7], s52 offen offset:0 sc1
    s_waitcnt lgkmcnt(10)
    buffer_store_dwordx4 v[100:103], v59, s[4:7], s52 offen offset:1024 sc1
    s_waitcnt lgkmcnt(9)
    buffer_store_dwordx4 v[104:107], v59, s[4:7], s52 offen offset:2048 sc1
    s_waitcnt lgkmcnt(8)
    buffer_store_dwordx4 v[108:111], v59, s[4:7], s52 offen offset:3072 sc1
    s_waitcnt lgkmcnt(7)
    s_add_u32 s52, s52, 4096
    buffer_store_dwordx4 v[112:115], v59, s[4:7], s52 offen offset:0 sc1
    s_waitcnt lgkmcnt(6)
    buffer_store_dwordx4 v[116:119], v59, s[4:7], s52 offen offset:1024 sc1
    s_waitcnt lgkmcnt(5)
    buffer_store_dwordx4 v[120:123], v59, s[4:7], s52 offen offset:2048 sc1
    s_waitcnt lgkmcnt(4)
    buffer_store_dwordx4 v[124:127], v59, s[4:7], s52 offen offset:3072 sc1
    s_waitcnt lgkmcnt(3)
    s_add_u32 s52, s52, 4096
    buffer_store_dwordx4 v[128:131], v59, s[4:7], s52 offen offset:0 sc1
    s_waitcnt lgkmcnt(2)
    buffer_store_dwordx4 v[132:135], v59, s[4:7], s52 offen offset:1024 sc1
    s_waitcnt lgkmcnt(1)
    buffer_store_dwordx4 v[136:139], v59, s[4:7], s52 offen offset:2048 sc1
    s_waitcnt lgkmcnt(0)
    buffer_store_dwordx4 v[140:143], v59, s[4:7], s52 offen offset:3072 sc1
Lhp_12:
    s_mov_b32 s16, s24
    s_and_b32 s17, s25, 0xffff
    s_mov_b32 s18, 819200
    s_mov_b32 s19, 0x20000
    s_mul_i32 s52, s45, 25600
    v_add_u32 v46, 0, v1
    v_min_u32 v46, 199, v46
    v_lshlrev_b32 v46, 7, v46
    buffer_load_dword v62, v46, s[16:19], s52 offen
    v_add_u32 v46, 64, v1
    v_min_u32 v46, 199, v46
    v_lshlrev_b32 v46, 7, v46
    buffer_load_dword v62, v46, s[16:19], s52 offen
    v_add_u32 v46, 128, v1
    v_min_u32 v46, 199, v46
    v_lshlrev_b32 v46, 7, v46
    buffer_load_dword v62, v46, s[16:19], s52 offen
    v_add_u32 v46, 192, v1
    v_min_u32 v46, 199, v46
    v_lshlrev_b32 v46, 7, v46
    buffer_load_dword v62, v46, s[16:19], s52 offen
    s_mov_b32 s16, s24
    s_and_b32 s17, s25, 0xffff
    s_mov_b32 s18, 819200
    s_mov_b32 s19, 0x20000
    v_mov_b32 v48, v1
    v_mul_u32_u24 v49, 6554, v48
    v_lshrrev_b32 v49, 16, v49
    v_mul_u32_u24 v49, 1120, v49
    v_lshl_add_u32 v50, v48, 4, v49
    v_add_u32 v48, 64, v48
    v_mul_u32_u24 v49, 6554, v48
    v_lshrrev_b32 v49, 16, v49
    v_mul_u32_u24 v49, 1120, v49
    v_lshl_add_u32 v51, v48, 4, v49
    v_add_u32 v48, 64, v48
    v_mul_u32_u24 v49, 6554, v48
    v_lshrrev_b32 v49, 16, v49
    v_mul_u32_u24 v49, 1120, v49
    v_lshl_add_u32 v52, v48, 4, v49
    v_add_u32 v48, 64, v48
    v_mul_u32_u24 v49, 6554, v48
    v_lshrrev_b32 v49, 16, v49
    v_mul_u32_u24 v49, 1120, v49
    v_lshl_add_u32 v53, v48, 4, v49
    v_add_u32 v48, 64, v48
    v_mul_u32_u24 v49, 6554, v48
    v_lshrrev_b32 v49, 16, v49
    v_mul_u32_u24 v49, 1120, v49
    v_lshl_add_u32 v54, v48, 4, v49
    s_mul_i32 s52, s48, 160
    s_mov_b32 m0, 61440
    s_add_u32 s54, s52, 0
    buffer_load_dwordx4 v50, s[16:19], s54 offen lds
    s_mov_b32 m0, 62464
    s_add_u32 s54, s52, 0
    buffer_load_dwordx4 v51, s[16:19], s54 offen lds
    s_mov_b32 m0, 63488
    s_add_u32 s54, s52, 0
    buffer_load_dwordx4 v52, s[16:19], s54 offen lds
    s_mov_b32 m0, 64512
    s_add_u32 s54, s52, 0
    buffer_load_dwordx4 v53, s[16:19], s54 offen lds
    s_mov_b32 m0, 65536
    s_add_u32 s54, s52, 0
    buffer_load_dwordx4 v54, s[16:19], s54 offen lds
    s_mov_b32 m0, 66560
    s_add_u32 s54, s52, 40960
    buffer_load_dwordx4 v50, s[16:19], s54 offen lds
    s_mov_b32 m0, 67584
    s_add_u32 s54, s52, 40960
    buffer_load_dwordx4 v51, s[16:19], s54 offen lds
    s_mov_b32 m0, 68608
    s_add_u32 s54, s52, 40960
    buffer_load_dwordx4 v52, s[16:19], s54 offen lds
    s_mov_b32 m0, 69632
    s_add_u32 s54, s52, 40960
    buffer_load_dwordx4 v53, s[16:19], s54 offen lds
    s_mov_b32 m0, 70656
    s_add_u32 s54, s52, 40960
    buffer_load_dwordx4 v54, s[16:19], s54 offen lds
    s_mov_b32 m0, 71680
    s_add_u32 s54, s52, 81920
    buffer_load_dwordx4 v50, s[16:19], s54 offen lds
    s_mov_b32 m0, 72704
    s_add_u32 s54, s52, 81920
    buffer_load_dwordx4 v51, s[16:19], s54 offen lds
    s_mov_b32 m0, 73728
    s_add_u32 s54, s52, 81920
    buffer_load_dwordx4 v52, s[16:19], s54 offen lds
    s_mov_b32 m0, 74752
    s_add_u32 s54, s52, 81920
    buffer_load_dwordx4 v53, s[16:19], s54 offen lds
    s_mov_b32 m0, 75776
    s_add_u32 s54, s52, 81920
    buffer_load_dwordx4 v54, s[16:19], s54 offen lds
    s_mov_b32 m0, 76800
    s_add_u32 s54, s52, 122880
    buffer_load_dwordx4 v50, s[16:19], s54 offen lds
    s_mov_b32 m0, 77824
    s_add_u32 s54, s52, 122880
    buffer_load_dwordx4 v51, s[16:19], s54 offen lds
    s_mov_b32 m0, 78848
    s_add_u32 s54, s52, 122880
    buffer_load_dwordx4 v52, s[16:19], s54 offen lds
    s_mov_b32 m0, 79872
    s_add_u32 s54, s52, 122880
    buffer_load_dwordx4 v53, s[16:19], s54 offen lds
    s_mov_b32 m0, 80896
    s_add_u32 s54, s52, 122880
    buffer_load_dwordx4 v54, s[16:19], s54 offen lds
    s_mov_b32 m0, 81920
    s_add_u32 s54, s52, 163840
    buffer_load_dwordx4 v50, s[16:19], s54 offen lds
    s_mov_b32 m0, 82944
    s_add_u32 s54, s52, 163840
    buffer_load_dwordx4 v51, s[16:19], s54 offen lds
    s_mov_b32 m0, 83968
    s_add_u32 s54, s52, 163840
    buffer_load_dwordx4 v52, s[16:19], s54 offen lds
    s_mov_b32 m0, 84992
    s_add_u32 s54, s52, 163840
    buffer_load_dwordx4 v53, s[16:19], s54 offen lds
    s_mov_b32 m0, 86016
    s_add_u32 s54, s52, 163840
    buffer_load_dwordx4 v54, s[16:19], s54 offen lds
    s_mov_b32 m0, 87040
    s_add_u32 s54, s52, 204800
    buffer_load_dwordx4 v50, s[16:19], s54 offen lds
    s_mov_b32 m0, 88064
    s_add_u32 s54, s52, 204800
    buffer_load_dwordx4 v51, s[16:19], s54 offen lds
    s_mov_b32 m0, 89088
    s_add_u32 s54, s52, 204800
    buffer_load_dwordx4 v52, s[16:19], s54 offen lds
    s_mov_b32 m0, 90112
    s_add_u32 s54, s52, 204800
    buffer_load_dwordx4 v53, s[16:19], s54 offen lds
    s_mov_b32 m0, 91136
    s_add_u32 s54, s52, 204800
    buffer_load_dwordx4 v54, s[16:19], s54 offen lds
    v_mov_b32 v47, 49408
    s_mov_b32 s66, 0x40000
L_kvfree:
    ds_read_b32 v46, v47
    s_waitcnt lgkmcnt(0)
    v_readfirstlane_b32 s52, v46
    s_nop 0
    s_cmp_eq_u32 s52, 4
    s_cbranch_scc1 L_kvfree_ok
    s_sub_u32 s66, s66, 1
    s_cmp_lg_u32 s66, 0
    s_cbranch_scc1 L_kvfree
L_kvfree_ok:
    s_waitcnt vmcnt(34)
    s_lshl_b32 s52, s49, 3
    s_add_u32 s52, s52, s44
    s_lshl_b32 s52, s52, 5
    s_add_u32 s52, s52, s45
    s_lshl_b32 s52, s52, 7
    s_add_u32 s52, s52, 16384
    v_mov_b32 v48, 1
    v_mov_b32 v49, 1
    v_mov_b32 v50, 1
    v_mov_b32 v51, 1
    v_mov_b32 v47, 0
    s_mov_b64 exec, 1
    buffer_store_dwordx4 v[48:51], v47, s[4:7], s52 offen sc1
    s_mov_b64 exec, -1
    s_mov_b32 s16, s24
    s_and_b32 s17, s25, 0xffff
    s_mov_b32 s18, 819200
    s_mov_b32 s19, 0x20000
    v_mov_b32 v48, v1
    v_mul_u32_u24 v49, 6554, v48
    v_lshrrev_b32 v49, 16, v49
    v_mul_u32_u24 v49, 1120, v49
    v_lshl_add_u32 v50, v48, 4, v49
    v_add_u32 v48, 64, v48
    v_mul_u32_u24 v49, 6554, v48
    v_lshrrev_b32 v49, 16, v49
    v_mul_u32_u24 v49, 1120, v49
    v_lshl_add_u32 v51, v48, 4, v49
    v_add_u32 v48, 64, v48
    v_mul_u32_u24 v49, 6554, v48
    v_lshrrev_b32 v49, 16, v49
    v_mul_u32_u24 v49, 1120, v49
    v_lshl_add_u32 v52, v48, 4, v49
    v_add_u32 v48, 64, v48
    v_mul_u32_u24 v49, 6554, v48
    v_lshrrev_b32 v49, 16, v49
    v_mul_u32_u24 v49, 1120, v49
    v_lshl_add_u32 v53, v48, 4, v49
    v_add_u32 v48, 64, v48
    v_mul_u32_u24 v49, 6554, v48
    v_lshrrev_b32 v49, 16, v49
    v_mul_u32_u24 v49, 1120, v49
    v_lshl_add_u32 v54, v48, 4, v49
    s_mul_i32 s52, s48, 160
    s_mov_b32 m0, 92160
    s_add_u32 s54, s52, 245760
    buffer_load_dwordx4 v50, s[16:19], s54 offen lds
    s_mov_b32 m0, 93184
    s_add_u32 s54, s52, 245760
    buffer_load_dwordx4 v51, s[16:19], s54 offen lds
    s_mov_b32 m0, 94208
    s_add_u32 s54, s52, 245760
    buffer_load_dwordx4 v52, s[16:19], s54 offen lds
    s_mov_b32 m0, 95232
    s_add_u32 s54, s52, 245760
    buffer_load_dwordx4 v53, s[16:19], s54 offen lds
    s_mov_b32 m0, 96256
    s_add_u32 s54, s52, 245760
    buffer_load_dwordx4 v54, s[16:19], s54 offen lds
    s_mov_b32 m0, 97280
    s_add_u32 s54, s52, 286720
    buffer_load_dwordx4 v50, s[16:19], s54 offen lds
    s_mov_b32 m0, 98304
    s_add_u32 s54, s52, 286720
    buffer_load_dwordx4 v51, s[16:19], s54 offen lds
    s_mov_b32 m0, 99328
    s_add_u32 s54, s52, 286720
    buffer_load_dwordx4 v52, s[16:19], s54 offen lds
    s_mov_b32 m0, 100352
    s_add_u32 s54, s52, 286720
    buffer_load_dwordx4 v53, s[16:19], s54 offen lds
    s_mov_b32 m0, 101376
    s_add_u32 s54, s52, 286720
    buffer_load_dwordx4 v54, s[16:19], s54 offen lds
    s_mov_b32 m0, 102400
    s_add_u32 s54, s52, 327680
    buffer_load_dwordx4 v50, s[16:19], s54 offen lds
    s_mov_b32 m0, 103424
    s_add_u32 s54, s52, 327680
    buffer_load_dwordx4 v51, s[16:19], s54 offen lds
    s_mov_b32 m0, 104448
    s_add_u32 s54, s52, 327680
    buffer_load_dwordx4 v52, s[16:19], s54 offen lds
    s_mov_b32 m0, 105472
    s_add_u32 s54, s52, 327680
    buffer_load_dwordx4 v53, s[16:19], s54 offen lds
    s_mov_b32 m0, 106496
    s_add_u32 s54, s52, 327680
    buffer_load_dwordx4 v54, s[16:19], s54 offen lds
    s_mov_b32 m0, 107520
    s_add_u32 s54, s52, 368640
    buffer_load_dwordx4 v50, s[16:19], s54 offen lds
    s_mov_b32 m0, 108544
    s_add_u32 s54, s52, 368640
    buffer_load_dwordx4 v51, s[16:19], s54 offen lds
    s_mov_b32 m0, 109568
    s_add_u32 s54, s52, 368640
    buffer_load_dwordx4 v52, s[16:19], s54 offen lds
    s_mov_b32 m0, 110592
    s_add_u32 s54, s52, 368640
    buffer_load_dwordx4 v53, s[16:19], s54 offen lds
    s_mov_b32 m0, 111616
    s_add_u32 s54, s52, 368640
    buffer_load_dwordx4 v54, s[16:19], s54 offen lds
    s_mov_b32 m0, 112640
    s_add_u32 s54, s52, 409600
    buffer_load_dwordx4 v50, s[16:19], s54 offen lds
    s_mov_b32 m0, 113664
    s_add_u32 s54, s52, 409600
    buffer_load_dwordx4 v51, s[16:19], s54 offen lds
    s_mov_b32 m0, 114688
    s_add_u32 s54, s52, 409600
    buffer_load_dwordx4 v52, s[16:19], s54 offen lds
    s_mov_b32 m0, 115712
    s_add_u32 s54, s52, 409600
    buffer_load_dwordx4 v53, s[16:19], s54 offen lds
    s_mov_b32 m0, 116736
    s_add_u32 s54, s52, 409600
    buffer_load_dwordx4 v54, s[16:19], s54 offen lds
    s_mov_b32 m0, 117760
    s_add_u32 s54, s52, 450560
    buffer_load_dwordx4 v50, s[16:19], s54 offen lds
    s_mov_b32 m0, 118784
    s_add_u32 s54, s52, 450560
    buffer_load_dwordx4 v51, s[16:19], s54 offen lds
    s_mov_b32 m0, 119808
    s_add_u32 s54, s52, 450560
    buffer_load_dwordx4 v52, s[16:19], s54 offen lds
    s_mov_b32 m0, 120832
    s_add_u32 s54, s52, 450560
    buffer_load_dwordx4 v53, s[16:19], s54 offen lds
    s_mov_b32 m0, 121856
    s_add_u32 s54, s52, 450560
    buffer_load_dwordx4 v54, s[16:19], s54 offen lds
    s_mov_b32 m0, 122880
    s_add_u32 s54, s52, 491520
    buffer_load_dwordx4 v50, s[16:19], s54 offen lds
    s_mov_b32 m0, 123904
    s_add_u32 s54, s52, 491520
    buffer_load_dwordx4 v51, s[16:19], s54 offen lds
    s_mul_i32 s52, s45, 10240
    s_add_u32 s52, s52, s51
    v_add_u32 v46, 0, v1
    v_min_u32 v46, 159, v46
    v_lshlrev_b32 v46, 6, v46
    s_add_u32 s53, s52, 4849664
    buffer_load_dword v62, v46, s[4:7], s53 offen
    v_add_u32 v46, 64, v1
    v_min_u32 v46, 159, v46
    v_lshlrev_b32 v46, 6, v46
    s_add_u32 s53, s52, 4849664
    buffer_load_dword v62, v46, s[4:7], s53 offen
    v_add_u32 v46, 128, v1
    v_min_u32 v46, 159, v46
    v_lshlrev_b32 v46, 6, v46
    s_add_u32 s53, s52, 4849664
    buffer_load_dword v62, v46, s[4:7], s53 offen
    s_cmp_eq_u32 s44, 0
    s_cbranch_scc1 L_nohf
    s_lshl_b32 s52, s49, 3
    s_add_u32 s52, s52, s44
    s_sub_u32 s52, s52, 1
    s_lshl_b32 s52, s52, 5
    s_add_u32 s52, s52, s45
    s_mul_i32 s54, s52, 24576
    s_add_u32 s54, s54, 12582912
    s_lshl_b32 s52, s52, 7
    s_add_u32 s52, s52, 16384
    v_and_b32 v47, 3, v1
    v_lshlrev_b32 v47, 2, v47
    s_mov_b32 s66, 0x40000
Lhf_13:
    buffer_load_dword v46, v47, s[4:7], s52 offen sc1
    s_waitcnt vmcnt(0)
    v_cmp_eq_u32 vcc, 1, v46
    s_nop 0
    s_cmp_eq_u32 vcc_lo, -1
    s_cbranch_scc1 Lhf_13_ok
    s_sub_u32 s66, s66, 1
    s_cmp_lg_u32 s66, 0
    s_cbranch_scc1 Lhf_13
Lhf_13_ok:
    s_mov_b32 s53, 0
    s_add_u32 s54, s54, s53
    s_add_u32 m0, s53, 24576
    s_add_u32 s55, s54, 0
    buffer_load_dwordx4 v22, s[4:7], s55 offen sc1 lds
    s_add_u32 m0, s53, 25600
    s_add_u32 s55, s54, 1024
    buffer_load_dwordx4 v22, s[4:7], s55 offen sc1 lds
    s_add_u32 m0, s53, 26624
    s_add_u32 s55, s54, 2048
    buffer_load_dwordx4 v22, s[4:7], s55 offen sc1 lds
    s_add_u32 m0, s53, 27648
    s_add_u32 s55, s54, 3072
    buffer_load_dwordx4 v22, s[4:7], s55 offen sc1 lds
    s_add_u32 m0, s53, 28672
    s_add_u32 s55, s54, 4096
    buffer_load_dwordx4 v22, s[4:7], s55 offen sc1 lds
    s_add_u32 m0, s53, 29696
    s_add_u32 s55, s54, 5120
    buffer_load_dwordx4 v22, s[4:7], s55 offen sc1 lds
    s_add_u32 m0, s53, 30720
    s_add_u32 s55, s54, 6144
    buffer_load_dwordx4 v22, s[4:7], s55 offen sc1 lds
    s_add_u32 m0, s53, 31744
    s_add_u32 s55, s54, 7168
    buffer_load_dwordx4 v22, s[4:7], s55 offen sc1 lds
    s_add_u32 m0, s53, 32768
    s_add_u32 s55, s54, 8192
    buffer_load_dwordx4 v22, s[4:7], s55 offen sc1 lds
    s_add_u32 m0, s53, 33792
    s_add_u32 s55, s54, 9216
    buffer_load_dwordx4 v22, s[4:7], s55 offen sc1 lds
    s_add_u32 m0, s53, 34816
    s_add_u32 s55, s54, 10240
    buffer_load_dwordx4 v22, s[4:7], s55 offen sc1 lds
    s_add_u32 m0, s53, 35840
    s_add_u32 s55, s54, 11264
    buffer_load_dwordx4 v22, s[4:7], s55 offen sc1 lds
    s_add_u32 m0, s53, 36864
    s_add_u32 s55, s54, 12288
    buffer_load_dwordx4 v22, s[4:7], s55 offen sc1 lds
    s_add_u32 m0, s53, 37888
    s_add_u32 s55, s54, 13312
    buffer_load_dwordx4 v22, s[4:7], s55 offen sc1 lds
    s_add_u32 m0, s53, 38912
    s_add_u32 s55, s54, 14336
    buffer_load_dwordx4 v22, s[4:7], s55 offen sc1 lds
    s_add_u32 m0, s53, 39936
    s_add_u32 s55, s54, 15360
    buffer_load_dwordx4 v22, s[4:7], s55 offen sc1 lds
    s_add_u32 m0, s53, 40960
    s_add_u32 s55, s54, 16384
    buffer_load_dwordx4 v22, s[4:7], s55 offen sc1 lds
    s_add_u32 m0, s53, 41984
    s_add_u32 s55, s54, 17408
    buffer_load_dwordx4 v22, s[4:7], s55 offen sc1 lds
    s_add_u32 m0, s53, 43008
    s_add_u32 s55, s54, 18432
    buffer_load_dwordx4 v22, s[4:7], s55 offen sc1 lds
    s_add_u32 m0, s53, 44032
    s_add_u32 s55, s54, 19456
    buffer_load_dwordx4 v22, s[4:7], s55 offen sc1 lds
    s_add_u32 m0, s53, 45056
    s_add_u32 s55, s54, 20480
    buffer_load_dwordx4 v22, s[4:7], s55 offen sc1 lds
    s_add_u32 m0, s53, 46080
    s_add_u32 s55, s54, 21504
    buffer_load_dwordx4 v22, s[4:7], s55 offen sc1 lds
    s_add_u32 m0, s53, 47104
    s_add_u32 s55, s54, 22528
    buffer_load_dwordx4 v22, s[4:7], s55 offen sc1 lds
    s_add_u32 m0, s53, 48128
    s_add_u32 s55, s54, 23552
    buffer_load_dwordx4 v22, s[4:7], s55 offen sc1 lds
    s_waitcnt vmcnt(0)
L_nohf:
    s_barrier
    s_branch L_mid_done
L_mid1:
    s_cmp_eq_u32 s44, 0
    s_cbranch_scc1 L_mid_done
    s_mov_b32 s66, 0x2000
    v_add_u32 v46, s81, v22
Lhc_14:
    s_waitcnt vmcnt(0)
    ds_read_b128 v[96:99], v46 offset:24576
    ds_read_b128 v[100:103], v46 offset:25600
    ds_read_b128 v[104:107], v46 offset:26624
    ds_read_b128 v[108:111], v46 offset:27648
    ds_read_b128 v[112:115], v46 offset:28672
    ds_read_b128 v[116:119], v46 offset:29696
    s_waitcnt lgkmcnt(4)
    v_max3_u32 v47, v96, v97, v98
    v_max3_u32 v47, v47, v99, v100
    v_max3_u32 v47, v47, v101, v102
    s_waitcnt lgkmcnt(2)
    v_max3_u32 v47, v47, v103, v104
    v_max3_u32 v47, v47, v105, v106
    v_max3_u32 v47, v47, v107, v108
    v_max3_u32 v47, v47, v109, v110
    s_waitcnt lgkmcnt(0)
    v_max3_u32 v47, v47, v111, v112
    v_max3_u32 v47, v47, v113, v114
    v_max3_u32 v47, v47, v115, v116
    v_max3_u32 v47, v47, v117, v118
    v_max_u32 v47, v47, v119
    v_cmp_eq_u32 vcc, -1, v47
    s_nop 0
    s_cmp_eq_u64 vcc, 0
    s_cbranch_scc1 Lhc_14_ok
    s_add_u32 m0, s81, 24576
    s_add_u32 s55, s80, 0
    buffer_load_dwordx4 v22, s[4:7], s55 offen sc1 lds
    s_add_u32 m0, s81, 25600
    s_add_u32 s55, s80, 1024
    buffer_load_dwordx4 v22, s[4:7], s55 offen sc1 lds
    s_add_u32 m0, s81, 26624
    s_add_u32 s55, s80, 2048
    buffer_load_dwordx4 v22, s[4:7], s55 offen sc1 lds
    s_add_u32 m0, s81, 27648
    s_add_u32 s55, s80, 3072
    buffer_load_dwordx4 v22, s[4:7], s55 offen sc1 lds
    s_add_u32 m0, s81, 28672
    s_add_u32 s55, s80, 4096
    buffer_load_dwordx4 v22, s[4:7], s55 offen sc1 lds
    s_add_u32 m0, s81, 29696
    s_add_u32 s55, s80, 5120
    buffer_load_dwordx4 v22, s[4:7], s55 offen sc1 lds
    s_sub_u32 s66, s66, 1
    s_cmp_lg_u32 s66, 0
    s_cbranch_scc1 Lhc_14
Lhc_14_ok:
    s_barrier
L_mid_done:
    s_cmp_eq_u32 s44, 0
    s_cbranch_scc1 L_nohalo0
    ds_read_b128 v[144:147], v22 offset:54784
    ds_read_b128 v[148:151], v22 offset:55808
    ds_read_b128 v[152:155], v22 offset:56832
    ds_read_b128 v[156:159], v22 offset:57856
    s_mov_b32 s85, 1536
    s_mul_i32 s52, s88, 1536
    s_add_u32 s52, s52, 24576
    v_add_u32 v40, s52, v44
    v_add_u32 v41, s52, v45
    s_mul_i32 s52, s87, 1536
    s_add_u32 s52, s52, 24576
    v_add_u32 v42, s52, v44
    v_add_u32 v43, s52, v45
    ds_read_b128 v[136:139], v40
    ds_read_b128 v[140:143], v40 offset:32
    ds_read_b128 v[176:179], v42
    ds_read_b128 v[180:183], v42 offset:32
    s_waitcnt lgkmcnt(2)
    v_mfma_f32_32x32x16_bf16 v[96:111], v[136:139], v[32:35], v[144:159]
    v_mfma_f32_32x32x16_bf16 v[96:111], v[140:143], v[36:39], v[96:111]
    s_waitcnt lgkmcnt(0)
    v_mfma_f32_32x32x16_bf16 v[160:175], v[176:179], v[24:27], v[144:159]
    v_mfma_f32_32x32x16_bf16 v[160:175], v[180:183], v[28:31], v[160:175]
    s_nop 5
    ds_read_b64_tr_b16 v[144:145], v41 offset:0
    ds_read_b64_tr_b16 v[146:147], v41 offset:384
    ds_read_b64_tr_b16 v[148:149], v41 offset:768
    ds_read_b64_tr_b16 v[150:151], v41 offset:1152
    s_cmp_eq_u32 s49, 0
    s_cbranch_scc0 Lw2_15
    s_add_u32 m0, s61, 122880
    s_add_u32 s54, s60, 491520
    buffer_load_dwordx4 v184, s[12:15], s54 offen lds
    s_add_u32 m0, s61, 123904
    s_add_u32 s54, s60, 491520
    buffer_load_dwordx4 v185, s[12:15], s54 offen lds
    s_add_u32 m0, s61, 124928
    s_add_u32 s54, s60, 491520
    buffer_load_dwordx4 v186, s[12:15], s54 offen lds
Lw2_15:
    s_sub_u32 s86, 8, s88
    v_add_u32 v40, s85, v40
    v_add_u32 v41, s85, v41
    s_sub_u32 s86, s86, 1
    s_cmp_eq_u32 s86, 0
    s_cbranch_scc1 Latt_16_last0
Latt_16_loop:
    ds_read_b128 v[136:139], v40
    ds_read_b128 v[140:143], v40 offset:32
    ds_read_b64_tr_b16 v[152:153], v41 offset:0
    ds_read_b64_tr_b16 v[154:155], v41 offset:384
    ds_read_b64_tr_b16 v[156:157], v41 offset:768
    ds_read_b64_tr_b16 v[158:159], v41 offset:1152
    s_sub_u32 s86, s86, 1
    s_cmp_eq_u32 s86, 0
    v_exp_f32 v96, v96
    v_exp_f32 v97, v97
    v_exp_f32 v98, v98
    v_exp_f32 v99, v99
    v_exp_f32 v100, v100
    v_exp_f32 v101, v101
    v_exp_f32 v102, v102
    v_exp_f32 v103, v103
    s_waitcnt lgkmcnt(4)
    v_mfma_f32_32x32x16_bf16 v[112:127], v[136:139], v[32:35], 0
    v_cvt_pk_bf16_f32 v128, v96, v97
    v_cvt_pk_bf16_f32 v129, v98, v99
    v_cvt_pk_bf16_f32 v130, v100, v101
    v_cvt_pk_bf16_f32 v131, v102, v103
    v_exp_f32 v104, v104
    v_exp_f32 v105, v105
    v_exp_f32 v106, v106
    v_exp_f32 v107, v107
    v_mfma_f32_32x32x16_bf16 v[112:127], v[140:143], v[36:39], v[112:127]
    v_exp_f32 v108, v108
    v_exp_f32 v109, v109
    v_exp_f32 v110, v110
    v_exp_f32 v111, v111
    v_mfma_f32_32x32x16_bf16 v[80:95], v[144:147], v[128:131], v[80:95]
    v_cvt_pk_bf16_f32 v132, v104, v105
    v_cvt_pk_bf16_f32 v133, v106, v107
    v_cvt_pk_bf16_f32 v134, v108, v109
    v_cvt_pk_bf16_f32 v135, v110, v111
    v_add_u32 v40, s85, v40
    v_add_u32 v41, s85, v41
    v_mfma_f32_32x32x16_bf16 v[80:95], v[148:151], v[132:135], v[80:95]
    s_cbranch_scc1 Latt_16_last1
    ds_read_b128 v[136:139], v40
    ds_read_b128 v[140:143], v40 offset:32
    ds_read_b64_tr_b16 v[144:145], v41 offset:0
    ds_read_b64_tr_b16 v[146:147], v41 offset:384
    ds_read_b64_tr_b16 v[148:149], v41 offset:768
    ds_read_b64_tr_b16 v[150:151], v41 offset:1152
    s_sub_u32 s86, s86, 1
    s_cmp_eq_u32 s86, 0
    v_exp_f32 v112, v112
    v_exp_f32 v113, v113
    v_exp_f32 v114, v114
    v_exp_f32 v115, v115
    v_exp_f32 v116, v116
    v_exp_f32 v117, v117
    v_exp_f32 v118, v118
    v_exp_f32 v119, v119
    s_waitcnt lgkmcnt(4)
    v_mfma_f32_32x32x16_bf16 v[96:111], v[136:139], v[32:35], 0
    v_cvt_pk_bf16_f32 v128, v112, v113
    v_cvt_pk_bf16_f32 v129, v114, v115
    v_cvt_pk_bf16_f32 v130, v116, v117
    v_cvt_pk_bf16_f32 v131, v118, v119
    v_exp_f32 v120, v120
    v_exp_f32 v121, v121
    v_exp_f32 v122, v122
    v_exp_f32 v123, v123
    v_mfma_f32_32x32x16_bf16 v[96:111], v[140:143], v[36:39], v[96:111]
    v_exp_f32 v124, v124
    v_exp_f32 v125, v125
    v_exp_f32 v126, v126
    v_exp_f32 v127, v127
    v_mfma_f32_32x32x16_bf16 v[80:95], v[152:155], v[128:131], v[80:95]
    v_cvt_pk_bf16_f32 v132, v120, v121
    v_cvt_pk_bf16_f32 v133, v122, v123
    v_cvt_pk_bf16_f32 v134, v124, v125
    v_cvt_pk_bf16_f32 v135, v126, v127
    v_add_u32 v40, s85, v40
    v_add_u32 v41, s85, v41
    v_mfma_f32_32x32x16_bf16 v[80:95], v[156:159], v[132:135], v[80:95]
    s_cbranch_scc0 Latt_16_loop
Latt_16_last0:
    v_exp_f32 v96, v96
    v_exp_f32 v97, v97
    v_exp_f32 v98, v98
    v_exp_f32 v99, v99
    v_exp_f32 v100, v100
    v_exp_f32 v101, v101
    v_exp_f32 v102, v102
    v_exp_f32 v103, v103
    v_cvt_pk_bf16_f32 v128, v96, v97
    v_cvt_pk_bf16_f32 v129, v98, v99
    v_cvt_pk_bf16_f32 v130, v100, v101
    v_cvt_pk_bf16_f32 v131, v102, v103
    v_exp_f32 v104, v104
    v_exp_f32 v105, v105
    v_exp_f32 v106, v106
    v_exp_f32 v107, v107
    v_exp_f32 v108, v108
    v_exp_f32 v109, v109
    v_exp_f32 v110, v110
    v_exp_f32 v111, v111
    s_waitcnt lgkmcnt(0)
    v_mfma_f32_32x32x16_bf16 v[80:95], v[144:147], v[128:131], v[80:95]
    v_cvt_pk_bf16_f32 v132, v104, v105
    v_cvt_pk_bf16_f32 v133, v106, v107
    v_cvt_pk_bf16_f32 v134, v108, v109
    v_cvt_pk_bf16_f32 v135, v110, v111
    s_nop 1
    v_mfma_f32_32x32x16_bf16 v[80:95], v[148:151], v[132:135], v[80:95]
    s_branch Latt_16_done
Latt_16_last1:
    v_exp_f32 v112, v112
    v_exp_f32 v113, v113
    v_exp_f32 v114, v114
    v_exp_f32 v115, v115
    v_exp_f32 v116, v116
    v_exp_f32 v117, v117
    v_exp_f32 v118, v118
    v_exp_f32 v119, v119
    v_cvt_pk_bf16_f32 v128, v112, v113
    v_cvt_pk_bf16_f32 v129, v114, v115
    v_cvt_pk_bf16_f32 v130, v116, v117
    v_cvt_pk_bf16_f32 v131, v118, v119
    v_exp_f32 v120, v120
    v_exp_f32 v121, v121
    v_exp_f32 v122, v122
    v_exp_f32 v123, v123
    v_exp_f32 v124, v124
    v_exp_f32 v125, v125
    v_exp_f32 v126, v126
    v_exp_f32 v127, v127
    s_waitcnt lgkmcnt(0)
    v_mfma_f32_32x32x16_bf16 v[80:95], v[152:155], v[128:131], v[80:95]
    v_cvt_pk_bf16_f32 v132, v120, v121
    v_cvt_pk_bf16_f32 v133, v122, v123
    v_cvt_pk_bf16_f32 v134, v124, v125
    v_cvt_pk_bf16_f32 v135, v126, v127
    s_nop 1
    v_mfma_f32_32x32x16_bf16 v[80:95], v[156:159], v[132:135], v[80:95]
Latt_16_done:
    ds_read_b64_tr_b16 v[144:145], v43 offset:0
    ds_read_b64_tr_b16 v[146:147], v43 offset:384
    ds_read_b64_tr_b16 v[148:149], v43 offset:768
    ds_read_b64_tr_b16 v[150:151], v43 offset:1152
    s_cmp_eq_u32 s49, 0
    s_cbranch_scc0 Lw2_17
    s_add_u32 m0, s61, 125952
    s_add_u32 s54, s60, 491520
    buffer_load_dwordx4 v187, s[12:15], s54 offen lds
    s_add_u32 m0, s61, 126976
    s_add_u32 s54, s60, 491520
    buffer_load_dwordx4 v188, s[12:15], s54 offen lds
    s_add_u32 m0, s61, 128000
    s_add_u32 s54, s60, 532480
    buffer_load_dwordx4 v184, s[12:15], s54 offen lds
    s_add_u32 m0, s61, 129024
    s_add_u32 s54, s60, 532480
    buffer_load_dwordx4 v185, s[12:15], s54 offen lds
Lw2_17:
    s_sub_u32 s86, 8, s87
    v_add_u32 v42, s85, v42
    v_add_u32 v43, s85, v43
    s_sub_u32 s86, s86, 1
    s_cmp_eq_u32 s86, 0
    s_cbranch_scc1 Latt_18_last0
Latt_18_loop:
    ds_read_b128 v[136:139], v42
    ds_read_b128 v[140:143], v42 offset:32
    ds_read_b64_tr_b16 v[152:153], v43 offset:0
    ds_read_b64_tr_b16 v[154:155], v43 offset:384
    ds_read_b64_tr_b16 v[156:157], v43 offset:768
    ds_read_b64_tr_b16 v[158:159], v43 offset:1152
    s_sub_u32 s86, s86, 1
    s_cmp_eq_u32 s86, 0
    v_exp_f32 v160, v160
    v_exp_f32 v161, v161
    v_exp_f32 v162, v162
    v_exp_f32 v163, v163
    v_exp_f32 v164, v164
    v_exp_f32 v165, v165
    v_exp_f32 v166, v166
    v_exp_f32 v167, v167
    s_waitcnt lgkmcnt(4)
    v_mfma_f32_32x32x16_bf16 v[112:127], v[136:139], v[24:27], 0
    v_cvt_pk_bf16_f32 v128, v160, v161
    v_cvt_pk_bf16_f32 v129, v162, v163
    v_cvt_pk_bf16_f32 v130, v164, v165
    v_cvt_pk_bf16_f32 v131, v166, v167
    v_exp_f32 v168, v168
    v_exp_f32 v169, v169
    v_exp_f32 v170, v170
    v_exp_f32 v171, v171
    v_mfma_f32_32x32x16_bf16 v[112:127], v[140:143], v[28:31], v[112:127]
    v_exp_f32 v172, v172
    v_exp_f32 v173, v173
    v_exp_f32 v174, v174
    v_exp_f32 v175, v175
    v_mfma_f32_32x32x16_bf16 v[64:79], v[144:147], v[128:131], v[64:79]
    v_cvt_pk_bf16_f32 v132, v168, v169
    v_cvt_pk_bf16_f32 v133, v170, v171
    v_cvt_pk_bf16_f32 v134, v172, v173
    v_cvt_pk_bf16_f32 v135, v174, v175
    v_add_u32 v42, s85, v42
    v_add_u32 v43, s85, v43
    v_mfma_f32_32x32x16_bf16 v[64:79], v[148:151], v[132:135], v[64:79]
    s_cbranch_scc1 Latt_18_last1
    ds_read_b128 v[136:139], v42
    ds_read_b128 v[140:143], v42 offset:32
    ds_read_b64_tr_b16 v[144:145], v43 offset:0
    ds_read_b64_tr_b16 v[146:147], v43 offset:384
    ds_read_b64_tr_b16 v[148:149], v43 offset:768
    ds_read_b64_tr_b16 v[150:151], v43 offset:1152
    s_sub_u32 s86, s86, 1
    s_cmp_eq_u32 s86, 0
    v_exp_f32 v112, v112
    v_exp_f32 v113, v113
    v_exp_f32 v114, v114
    v_exp_f32 v115, v115
    v_exp_f32 v116, v116
    v_exp_f32 v117, v117
    v_exp_f32 v118, v118
    v_exp_f32 v119, v119
    s_waitcnt lgkmcnt(4)
    v_mfma_f32_32x32x16_bf16 v[160:175], v[136:139], v[24:27], 0
    v_cvt_pk_bf16_f32 v128, v112, v113
    v_cvt_pk_bf16_f32 v129, v114, v115
    v_cvt_pk_bf16_f32 v130, v116, v117
    v_cvt_pk_bf16_f32 v131, v118, v119
    v_exp_f32 v120, v120
    v_exp_f32 v121, v121
    v_exp_f32 v122, v122
    v_exp_f32 v123, v123
    v_mfma_f32_32x32x16_bf16 v[160:175], v[140:143], v[28:31], v[160:175]
    v_exp_f32 v124, v124
    v_exp_f32 v125, v125
    v_exp_f32 v126, v126
    v_exp_f32 v127, v127
    v_mfma_f32_32x32x16_bf16 v[64:79], v[152:155], v[128:131], v[64:79]
    v_cvt_pk_bf16_f32 v132, v120, v121
    v_cvt_pk_bf16_f32 v133, v122, v123
    v_cvt_pk_bf16_f32 v134, v124, v125
    v_cvt_pk_bf16_f32 v135, v126, v127
    v_add_u32 v42, s85, v42
    v_add_u32 v43, s85, v43
    v_mfma_f32_32x32x16_bf16 v[64:79], v[156:159], v[132:135], v[64:79]
    s_cbranch_scc0 Latt_18_loop
Latt_18_last0:
    v_exp_f32 v160, v160
    v_exp_f32 v161, v161
    v_exp_f32 v162, v162
    v_exp_f32 v163, v163
    v_exp_f32 v164, v164
    v_exp_f32 v165, v165
    v_exp_f32 v166, v166
    v_exp_f32 v167, v167
    v_cvt_pk_bf16_f32 v128, v160, v161
    v_cvt_pk_bf16_f32 v129, v162, v163
    v_cvt_pk_bf16_f32 v130, v164, v165
    v_cvt_pk_bf16_f32 v131, v166, v167
    v_exp_f32 v168, v168
    v_exp_f32 v169, v169
    v_exp_f32 v170, v170
    v_exp_f32 v171, v171
    v_exp_f32 v172, v172
    v_exp_f32 v173, v173
    v_exp_f32 v174, v174
    v_exp_f32 v175, v175
    s_waitcnt lgkmcnt(0)
    v_mfma_f32_32x32x16_bf16 v[64:79], v[144:147], v[128:131], v[64:79]
    v_cvt_pk_bf16_f32 v132, v168, v169
    v_cvt_pk_bf16_f32 v133, v170, v171
    v_cvt_pk_bf16_f32 v134, v172, v173
    v_cvt_pk_bf16_f32 v135, v174, v175
    s_nop 1
    v_mfma_f32_32x32x16_bf16 v[64:79], v[148:151], v[132:135], v[64:79]
    s_branch Latt_18_done
Latt_18_last1:
    v_exp_f32 v112, v112
    v_exp_f32 v113, v113
    v_exp_f32 v114, v114
    v_exp_f32 v115, v115
    v_exp_f32 v116, v116
    v_exp_f32 v117, v117
    v_exp_f32 v118, v118
    v_exp_f32 v119, v119
    v_cvt_pk_bf16_f32 v128, v112, v113
    v_cvt_pk_bf16_f32 v129, v114, v115
    v_cvt_pk_bf16_f32 v130, v116, v117
    v_cvt_pk_bf16_f32 v131, v118, v119
    v_exp_f32 v120, v120
    v_exp_f32 v121, v121
    v_exp_f32 v122, v122
    v_exp_f32 v123, v123
    v_exp_f32 v124, v124
    v_exp_f32 v125, v125
    v_exp_f32 v126, v126
    v_exp_f32 v127, v127
    s_waitcnt lgkmcnt(0)
    v_mfma_f32_32x32x16_bf16 v[64:79], v[152:155], v[128:131], v[64:79]
    v_cvt_pk_bf16_f32 v132, v120, v121
    v_cvt_pk_bf16_f32 v133, v122, v123
    v_cvt_pk_bf16_f32 v134, v124, v125
    v_cvt_pk_bf16_f32 v135, v126, v127
    s_nop 1
    v_mfma_f32_32x32x16_bf16 v[64:79], v[156:159], v[132:135], v[64:79]
Latt_18_done:
    s_branch L_nohalo
L_nohalo0:
    s_cmp_eq_u32 s49, 0
    s_cbranch_scc0 Lw2_19
    s_add_u32 m0, s61, 122880
    s_add_u32 s54, s60, 491520
    buffer_load_dwordx4 v184, s[12:15], s54 offen lds
    s_add_u32 m0, s61, 123904
    s_add_u32 s54, s60, 491520
    buffer_load_dwordx4 v185, s[12:15], s54 offen lds
    s_add_u32 m0, s61, 124928
    s_add_u32 s54, s60, 491520
    buffer_load_dwordx4 v186, s[12:15], s54 offen lds
    s_add_u32 m0, s61, 125952
    s_add_u32 s54, s60, 491520
    buffer_load_dwordx4 v187, s[12:15], s54 offen lds
    s_add_u32 m0, s61, 126976
    s_add_u32 s54, s60, 491520
    buffer_load_dwordx4 v188, s[12:15], s54 offen lds
    s_add_u32 m0, s61, 128000
    s_add_u32 s54, s60, 532480
    buffer_load_dwordx4 v184, s[12:15], s54 offen lds
    s_add_u32 m0, s61, 129024
    s_add_u32 s54, s60, 532480
    buffer_load_dwordx4 v185, s[12:15], s54 offen lds
Lw2_19:
L_nohalo:
    s_cmp_eq_u32 s49, 0
    s_cbranch_scc0 Lw2_20
    s_add_u32 m0, s61, 130048
    s_add_u32 s54, s60, 532480
    buffer_load_dwordx4 v186, s[12:15], s54 offen lds
    s_add_u32 m0, s61, 131072
    s_add_u32 s54, s60, 532480
    buffer_load_dwordx4 v187, s[12:15], s54 offen lds
    s_add_u32 m0, s61, 132096
    s_add_u32 s54, s60, 532480
    buffer_load_dwordx4 v188, s[12:15], s54 offen lds
Lw2_20:
    s_cmp_eq_u32 s49, 0
    s_cbranch_scc0 Lys_21
    s_waitcnt vmcnt(0)
    v_mov_b32 v46, 1
    v_mov_b32 v47, 49412
    s_mov_b64 exec, 1
    ds_add_rtn_u32 v46, v47, v46
    s_mov_b64 exec, -1
    s_waitcnt lgkmcnt(0)
    v_readfirstlane_b32 s56, v46
    s_nop 0
    s_cmp_eq_u32 s56, 3
    s_cbranch_scc0 Lys_21
    s_lshl_b32 s52, s44, 8
    s_lshl_b32 s53, s45, 2
    s_add_u32 s52, s52, s53
    s_add_u32 s52, s52, 8192
    v_mov_b32 v46, 1
    v_mov_b32 v47, 0
    s_mov_b64 exec, 1
    buffer_store_dword v46, v47, s[4:7], s52 offen sc1
    s_mov_b64 exec, -1
Lys_21:
    v_mov_b32 v46, v88
    v_mov_b32 v47, v88
    s_mul_i32 s52, s88, 40960
    s_add_u32 s52, s52, s51
    v_permlane32_swap_b32 v46, v47
    s_add_u32 s58, s52, 4849664
    v_cmp_lt_f32 vcc, 0x1f800000, v47
    v_cmp_gt_f32 s[56:57], s96, v47
    v_rcp_f32 v48, v47
    s_and_b64 s[56:57], s[56:57], vcc
    s_cmp_eq_u64 s[56:57], -1
    s_cbranch_scc0 Lfin_22_fb
Lfin_22_ok:
    v_pk_mul_f32 v[80:81], v[80:81], v[48:49] op_sel_hi:[1,0]
    v_pk_mul_f32 v[82:83], v[82:83], v[48:49] op_sel_hi:[1,0]
    v_pk_mul_f32 v[84:85], v[84:85], v[48:49] op_sel_hi:[1,0]
    v_pk_mul_f32 v[86:87], v[86:87], v[48:49] op_sel_hi:[1,0]
    v_pk_mul_f32 v[88:89], v[88:89], v[48:49] op_sel_hi:[1,0]
    v_pk_mul_f32 v[90:91], v[90:91], v[48:49] op_sel_hi:[1,0]
    v_cvt_pk_bf16_f32 v100, v80, v81
    v_cvt_pk_bf16_f32 v101, v82, v83
    v_cvt_pk_bf16_f32 v102, v84, v85
    v_cvt_pk_bf16_f32 v103, v86, v87
    v_cvt_pk_bf16_f32 v104, v88, v89
    v_cvt_pk_bf16_f32 v105, v90, v91
    buffer_store_dwordx2 v[100:101], v189, s[4:7], s58 offen
    buffer_store_dwordx2 v[102:103], v190, s[4:7], s58 offen
    s_mov_b32 exec_hi, 0
    buffer_store_dwordx2 v[104:105], v191, s[4:7], s58 offen
    s_mov_b32 exec_hi, -1
    v_mov_b32 v46, v72
    v_mov_b32 v47, v72
    s_mul_i32 s52, s87, 40960
    s_add_u32 s52, s52, s51
    v_permlane32_swap_b32 v46, v47
    s_add_u32 s58, s52, 4849664
    v_cmp_lt_f32 vcc, 0x1f800000, v47
    v_cmp_gt_f32 s[56:57], s96, v47
    v_rcp_f32 v48, v47
    s_and_b64 s[56:57], s[56:57], vcc
    s_cmp_eq_u64 s[56:57], -1
    s_cbranch_scc0 Lfin_23_fb
Lfin_23_ok:
    v_pk_mul_f32 v[64:65], v[64:65], v[48:49] op_sel_hi:[1,0]
    v_pk_mul_f32 v[66:67], v[66:67], v[48:49] op_sel_hi:[1,0]
    v_pk_mul_f32 v[68:69], v[68:69], v[48:49] op_sel_hi:[1,0]
    v_pk_mul_f32 v[70:71], v[70:71], v[48:49] op_sel_hi:[1,0]
    v_pk_mul_f32 v[72:73], v[72:73], v[48:49] op_sel_hi:[1,0]
    v_pk_mul_f32 v[74:75], v[74:75], v[48:49] op_sel_hi:[1,0]
    v_cvt_pk_bf16_f32 v100, v64, v65
    v_cvt_pk_bf16_f32 v101, v66, v67
    v_cvt_pk_bf16_f32 v102, v68, v69
    v_cvt_pk_bf16_f32 v103, v70, v71
    v_cvt_pk_bf16_f32 v104, v72, v73
    v_cvt_pk_bf16_f32 v105, v74, v75
    buffer_store_dwordx2 v[100:101], v189, s[4:7], s58 offen
    buffer_store_dwordx2 v[102:103], v190, s[4:7], s58 offen
    s_mov_b32 exec_hi, 0
    buffer_store_dwordx2 v[104:105], v191, s[4:7], s58 offen
    s_mov_b32 exec_hi, -1
    s_mul_i32 s95, s49, 3
    s_add_u32 s95, s95, 3
    s_waitcnt vmcnt(0)
    v_mov_b32 v44, s95
    s_cmp_eq_u32 s46, 0
    s_barrier
    s_cbranch_scc0 Lsg_24
    s_mov_b64 exec, 1
    s_cmp_eq_u32 s50, 1
    s_cbranch_scc0 Lsig_25_slow
    buffer_store_dword v44, v22, s[4:7], s67 offen
Lsig_25_done:
    s_mov_b64 exec, -1
Lsg_24:
    s_lshl_b32 s70, s47, 2
    s_add_u32 s70, s70, s46
    s_mul_i32 s70, s70, 20480
    s_add_u32 s70, s70, s51
    s_add_u32 s70, s70, 4849664
    v_lshrrev_b32 v44, 4, v1
    v_lshrrev_b32 v45, 1, v44
    v_lshlrev_b32 v45, 4, v45
    v_and_b32 v44, 1, v44
    v_lshl_add_u32 v45, v44, 2, v45
    v_bfe_u32 v44, v1, 2, 2
    v_add_u32 v45, v45, v44
    v_mul_u32_u24 v45, 160, v45
    v_and_b32 v44, 3, v1
    v_lshl_add_u32 v45, v44, 3, v45
    v_add_u32 v48, 61440, v45
    v_add_u32 v49, 112640, v45
    v_and_b32 v56, 15, v1
    v_lshlrev_b32 v56, 4, v56
    v_bfe_u32 v44, v1, 4, 1
    v_lshl_add_u32 v56, v44, 10, v56
    v_lshrrev_b32 v44, 5, v1
    v_lshl_add_u32 v56, v44, 9, v56
    s_lshl_b32 s72, s49, 18
    s_add_u32 s72, s72, s62
    s_add_u32 s72, s72, 131072
    v_lshrrev_b32 v44, 4, v1
    v_lshrrev_b32 v57, 1, v44
    v_lshlrev_b32 v57, 9, v57
    v_and_b32 v44, 1, v44
    v_lshl_add_u32 v57, v44, 3, v57
    v_and_b32 v44, 15, v1
    v_lshl_add_u32 v57, v44, 4, v57
    s_lshl_b32 s71, s48, 8
    s_add_u32 s71, s71, 8192
    v_and_b32 v180, 15, v1
    v_mul_u32_u24 v180, 160, v180
    v_lshrrev_b32 v181, 4, v1
    v_lshl_add_u32 v180, v181, 3, v180
    s_lshl_b32 s52, s46, 12
    v_add_u32 v180, s52, v180
    v_add_u32 v181, s52, v22
    s_lshl_b32 s52, s44, 8
    s_lshl_b32 s53, s47, 6
    s_add_u32 s52, s52, s53
    s_lshl_b32 s53, s46, 4
    s_add_u32 s52, s52, s53
    s_mul_i32 s52, s52, 1280
    s_mul_i32 s53, s48, 160
    s_add_u32 s73, s52, s53
    v_mov_b32 v185, v1
    v_mul_u32_u24 v186, 6554, v185
    v_lshrrev_b32 v186, 16, v186
    v_mul_u32_u24 v186, 1120, v186
    v_lshl_add_u32 v182, v185, 4, v186
    v_add_u32 v185, 64, v185
    v_mul_u32_u24 v186, 6554, v185
    v_lshrrev_b32 v186, 16, v186
    v_mul_u32_u24 v186, 1120, v186
    v_lshl_add_u32 v183, v185, 4, v186
    v_add_u32 v185, 64, v185
    v_mul_u32_u24 v186, 6554, v185
    v_lshrrev_b32 v186, 16, v186
    v_mul_u32_u24 v186, 1120, v186
    v_lshl_add_u32 v184, v185, 4, v186
    s_mov_b32 s8, s38
    s_and_b32 s9, s39, 0xffff
    s_mov_b32 s10, 2621440
    s_mov_b32 s11, 0x20000
    ds_read_b64_tr_b16 v[96:97], v48 offset:0
    ds_read_b64_tr_b16 v[98:99], v48 offset:1280
    ds_read_b64_tr_b16 v[100:101], v48 offset:32
    ds_read_b64_tr_b16 v[102:103], v48 offset:1312
    ds_read_b64_tr_b16 v[104:105], v48 offset:64
    ds_read_b64_tr_b16 v[106:107], v48 offset:1344
    ds_read_b64_tr_b16 v[108:109], v48 offset:96
    ds_read_b64_tr_b16 v[110:111], v48 offset:1376
    ds_read_b64_tr_b16 v[112:113], v48 offset:128
    ds_read_b64_tr_b16 v[114:115], v48 offset:1408
    ds_read_b64_tr_b16 v[116:117], v48 offset:5120
    ds_read_b64_tr_b16 v[118:119], v48 offset:6400
    ds_read_b64_tr_b16 v[120:121], v48 offset:5152
    ds_read_b64_tr_b16 v[122:123], v48 offset:6432
    ds_read_b64_tr_b16 v[124:125], v48 offset:5184
    ds_read_b64_tr_b16 v[126:127], v48 offset:6464
    ds_read_b64_tr_b16 v[128:129], v48 offset:5216
    ds_read_b64_tr_b16 v[130:131], v48 offset:6496
    ds_read_b64_tr_b16 v[132:133], v48 offset:5248
    ds_read_b64_tr_b16 v[134:135], v48 offset:6528
    s_mov_b32 s66, 0x40000
Lwl_26:
    buffer_load_dword v44, v0, s[4:7], s64 offen sc1
    s_waitcnt vmcnt(0)
    v_cmp_le_u32 vcc, s95, v44
    s_nop 0
    s_cmp_eq_u32 vcc_lo, -1
    s_cbranch_scc0 Lwl_26_retry
Lwl_26_ok:
    s_cmp_eq_u32 s50, 1
    s_cbranch_scc0 Lwl_26_inv
Lwl_26_fin:
    buffer_load_dwordx4 v[64:67], v22, s[4:7], s70 offen offset:0 sc1
    buffer_load_dwordx4 v[68:71], v22, s[4:7], s70 offen offset:1024 sc1
    buffer_load_dwordx4 v[72:75], v22, s[4:7], s70 offen offset:2048 sc1
    buffer_load_dwordx4 v[76:79], v22, s[4:7], s70 offen offset:3072 sc1
    s_add_u32 s70, s70, 4096
    buffer_load_dwordx4 v[80:83], v22, s[4:7], s70 offen offset:0 sc1
    buffer_load_dwordx4 v[84:87], v22, s[4:7], s70 offen offset:1024 sc1
    buffer_load_dwordx4 v[88:91], v22, s[4:7], s70 offen offset:2048 sc1
    s_waitcnt vmcnt(6)
    s_waitcnt lgkmcnt(10)
    v_mfma_f32_16x16x32_bf16 v[160:163], v[96:99], v[64:67], 0
    ds_read_b64_tr_b16 v[136:137], v48 offset:10240
    ds_read_b64_tr_b16 v[138:139], v48 offset:11520
    v_mfma_f32_16x16x32_bf16 v[164:167], v[100:103], v[64:67], 0
    ds_read_b64_tr_b16 v[140:141], v48 offset:10272
    ds_read_b64_tr_b16 v[142:143], v48 offset:11552
    v_mfma_f32_16x16x32_bf16 v[168:171], v[104:107], v[64:67], 0
    ds_read_b64_tr_b16 v[144:145], v48 offset:10304
    ds_read_b64_tr_b16 v[146:147], v48 offset:11584
    v_mfma_f32_16x16x32_bf16 v[172:175], v[108:111], v[64:67], 0
    ds_read_b64_tr_b16 v[148:149], v48 offset:10336
    ds_read_b64_tr_b16 v[150:151], v48 offset:11616
    v_mfma_f32_16x16x32_bf16 v[176:179], v[112:115], v[64:67], 0
    ds_read_b64_tr_b16 v[152:153], v48 offset:10368
    ds_read_b64_tr_b16 v[154:155], v48 offset:11648
    buffer_load_dwordx4 v[92:95], v22, s[4:7], s70 offen offset:3072 sc1
    s_waitcnt vmcnt(6)
    s_waitcnt lgkmcnt(10)
    v_mfma_f32_16x16x32_bf16 v[160:163], v[116:119], v[68:71], v[160:163]
    ds_read_b64_tr_b16 v[96:97], v48 offset:15360
    ds_read_b64_tr_b16 v[98:99], v48 offset:16640
    v_mfma_f32_16x16x32_bf16 v[164:167], v[120:123], v[68:71], v[164:167]
    ds_read_b64_tr_b16 v[100:101], v48 offset:15392
    ds_read_b64_tr_b16 v[102:103], v48 offset:16672
    v_mfma_f32_16x16x32_bf16 v[168:171], v[124:127], v[68:71], v[168:171]
    ds_read_b64_tr_b16 v[104:105], v48 offset:15424
    ds_read_b64_tr_b16 v[106:107], v48 offset:16704
    v_mfma_f32_16x16x32_bf16 v[172:175], v[128:131], v[68:71], v[172:175]
    ds_read_b64_tr_b16 v[108:109], v48 offset:15456
    ds_read_b64_tr_b16 v[110:111], v48 offset:16736
    v_mfma_f32_16x16x32_bf16 v[176:179], v[132:135], v[68:71], v[176:179]
    ds_read_b64_tr_b16 v[112:113], v48 offset:15488
    ds_read_b64_tr_b16 v[114:115], v48 offset:16768
    s_add_u32 s70, s70, 4096
    buffer_load_dwordx4 v[64:67], v22, s[4:7], s70 offen offset:0 sc1
    buffer_load_dword v50, v0, s[4:7], s71 offen sc1
    s_waitcnt vmcnt(7)
    s_waitcnt lgkmcnt(10)
    v_mfma_f32_16x16x32_bf16 v[160:163], v[136:139], v[72:75], v[160:163]
    ds_read_b64_tr_b16 v[116:117], v48 offset:20480
    ds_read_b64_tr_b16 v[118:119], v48 offset:21760
    v_mfma_f32_16x16x32_bf16 v[164:167], v[140:143], v[72:75], v[164:167]
    ds_read_b64_tr_b16 v[120:121], v48 offset:20512
    ds_read_b64_tr_b16 v[122:123], v48 offset:21792
    v_mfma_f32_16x16x32_bf16 v[168:171], v[144:147], v[72:75], v[168:171]
    ds_read_b64_tr_b16 v[124:125], v48 offset:20544
    ds_read_b64_tr_b16 v[126:127], v48 offset:21824
    v_mfma_f32_16x16x32_bf16 v[172:175], v[148:151], v[72:75], v[172:175]
    ds_read_b64_tr_b16 v[128:129], v48 offset:20576
    ds_read_b64_tr_b16 v[130:131], v48 offset:21856
    v_mfma_f32_16x16x32_bf16 v[176:179], v[152:155], v[72:75], v[176:179]
    ds_read_b64_tr_b16 v[132:133], v48 offset:20608
    ds_read_b64_tr_b16 v[134:135], v48 offset:21888
    buffer_load_dwordx4 v[68:71], v22, s[4:7], s70 offen offset:1024 sc1
    s_waitcnt vmcnt(7)
    s_waitcnt lgkmcnt(10)
    v_mfma_f32_16x16x32_bf16 v[160:163], v[96:99], v[76:79], v[160:163]
    ds_read_b64_tr_b16 v[136:137], v48 offset:25600
    ds_read_b64_tr_b16 v[138:139], v48 offset:26880
    v_mfma_f32_16x16x32_bf16 v[164:167], v[100:103], v[76:79], v[164:167]
    ds_read_b64_tr_b16 v[140:141], v48 offset:25632
    ds_read_b64_tr_b16 v[142:143], v48 offset:26912
    v_mfma_f32_16x16x32_bf16 v[168:171], v[104:107], v[76:79], v[168:171]
    ds_read_b64_tr_b16 v[144:145], v48 offset:25664
    ds_read_b64_tr_b16 v[146:147], v48 offset:26944
    v_mfma_f32_16x16x32_bf16 v[172:175], v[108:111], v[76:79], v[172:175]
    ds_read_b64_tr_b16 v[148:149], v48 offset:25696
    ds_read_b64_tr_b16 v[150:151], v48 offset:26976
    v_mfma_f32_16x16x32_bf16 v[176:179], v[112:115], v[76:79], v[176:179]
    ds_read_b64_tr_b16 v[152:153], v48 offset:25728
    ds_read_b64_tr_b16 v[154:155], v48 offset:27008
    buffer_load_dwordx4 v[72:75], v22, s[4:7], s70 offen offset:2048 sc1
    s_waitcnt vmcnt(7)
    s_waitcnt lgkmcnt(10)
    v_mfma_f32_16x16x32_bf16 v[160:163], v[116:119], v[80:83], v[160:163]
    ds_read_b64_tr_b16 v[96:97], v48 offset:30720
    ds_read_b64_tr_b16 v[98:99], v48 offset:32000
    v_mfma_f32_16x16x32_bf16 v[164:167], v[120:123], v[80:83], v[164:167]
    ds_read_b64_tr_b16 v[100:101], v48 offset:30752
    ds_read_b64_tr_b16 v[102:103], v48 offset:32032
    v_mfma_f32_16x16x32_bf16 v[168:171], v[124:127], v[80:83], v[168:171]
    ds_read_b64_tr_b16 v[104:105], v48 offset:30784
    ds_read_b64_tr_b16 v[106:107], v48 offset:32064
    v_mfma_f32_16x16x32_bf16 v[172:175], v[128:131], v[80:83], v[172:175]
    ds_read_b64_tr_b16 v[108:109], v48 offset:30816
    ds_read_b64_tr_b16 v[110:111], v48 offset:32096
    v_mfma_f32_16x16x32_bf16 v[176:179], v[132:135], v[80:83], v[176:179]
    ds_read_b64_tr_b16 v[112:113], v48 offset:30848
    ds_read_b64_tr_b16 v[114:115], v48 offset:32128
    buffer_load_dwordx4 v[76:79], v22, s[4:7], s70 offen offset:3072 sc1
    s_waitcnt vmcnt(7)
    s_waitcnt lgkmcnt(10)
    v_mfma_f32_16x16x32_bf16 v[160:163], v[136:139], v[84:87], v[160:163]
    ds_read_b64_tr_b16 v[116:117], v48 offset:35840
    ds_read_b64_tr_b16 v[118:119], v48 offset:37120
    v_mfma_f32_16x16x32_bf16 v[164:167], v[140:143], v[84:87], v[164:167]
    ds_read_b64_tr_b16 v[120:121], v48 offset:35872
    ds_read_b64_tr_b16 v[122:123], v48 offset:37152
    v_mfma_f32_16x16x32_bf16 v[168:171], v[144:147], v[84:87], v[168:171]
    ds_read_b64_tr_b16 v[124:125], v48 offset:35904
    ds_read_b64_tr_b16 v[126:127], v48 offset:37184
    v_mfma_f32_16x16x32_bf16 v[172:175], v[148:151], v[84:87], v[172:175]
    ds_read_b64_tr_b16 v[128:129], v48 offset:35936
    ds_read_b64_tr_b16 v[130:131], v48 offset:37216
    v_mfma_f32_16x16x32_bf16 v[176:179], v[152:155], v[84:87], v[176:179]
    ds_read_b64_tr_b16 v[132:133], v48 offset:35968
    ds_read_b64_tr_b16 v[134:135], v48 offset:37248
    s_add_u32 s70, s70, 4096
    buffer_load_dwordx4 v[80:83], v22, s[4:7], s70 offen offset:0 sc1
    s_waitcnt vmcnt(7)
    s_waitcnt lgkmcnt(10)
    v_mfma_f32_16x16x32_bf16 v[160:163], v[96:99], v[88:91], v[160:163]
    ds_read_b64_tr_b16 v[136:137], v48 offset:40960
    ds_read_b64_tr_b16 v[138:139], v48 offset:42240
    v_mfma_f32_16x16x32_bf16 v[164:167], v[100:103], v[88:91], v[164:167]
    ds_read_b64_tr_b16 v[140:141], v48 offset:40992
    ds_read_b64_tr_b16 v[142:143], v48 offset:42272
    v_mfma_f32_16x16x32_bf16 v[168:171], v[104:107], v[88:91], v[168:171]
    ds_read_b64_tr_b16 v[144:145], v48 offset:41024
    ds_read_b64_tr_b16 v[146:147], v48 offset:42304
    v_mfma_f32_16x16x32_bf16 v[172:175], v[108:111], v[88:91], v[172:175]
    ds_read_b64_tr_b16 v[148:149], v48 offset:41056
    ds_read_b64_tr_b16 v[150:151], v48 offset:42336
    v_mfma_f32_16x16x32_bf16 v[176:179], v[112:115], v[88:91], v[176:179]
    ds_read_b64_tr_b16 v[152:153], v48 offset:41088
    ds_read_b64_tr_b16 v[154:155], v48 offset:42368
    buffer_load_dwordx4 v[84:87], v22, s[4:7], s70 offen offset:1024 sc1
    s_waitcnt vmcnt(7)
    s_waitcnt lgkmcnt(10)
    v_mfma_f32_16x16x32_bf16 v[160:163], v[116:119], v[92:95], v[160:163]
    ds_read_b64_tr_b16 v[96:97], v48 offset:46080
    ds_read_b64_tr_b16 v[98:99], v48 offset:47360
    v_mfma_f32_16x16x32_bf16 v[164:167], v[120:123], v[92:95], v[164:167]
    ds_read_b64_tr_b16 v[100:101], v48 offset:46112
    ds_read_b64_tr_b16 v[102:103], v48 offset:47392
    v_mfma_f32_16x16x32_bf16 v[168:171], v[124:127], v[92:95], v[168:171]
    ds_read_b64_tr_b16 v[104:105], v48 offset:46144
    ds_read_b64_tr_b16 v[106:107], v48 offset:47424
    v_mfma_f32_16x16x32_bf16 v[172:175], v[128:131], v[92:95], v[172:175]
    ds_read_b64_tr_b16 v[108:109], v48 offset:46176
    ds_read_b64_tr_b16 v[110:111], v48 offset:47456
    v_mfma_f32_16x16x32_bf16 v[176:179], v[132:135], v[92:95], v[176:179]
    ds_read_b64_tr_b16 v[112:113], v48 offset:46208
    ds_read_b64_tr_b16 v[114:115], v48 offset:47488
    buffer_load_dwordx4 v[88:91], v22, s[4:7], s70 offen offset:2048 sc1
    s_waitcnt vmcnt(7)
    s_waitcnt lgkmcnt(10)
    v_mfma_f32_16x16x32_bf16 v[160:163], v[136:139], v[64:67], v[160:163]
    ds_read_b64_tr_b16 v[116:117], v49 offset:0
    ds_read_b64_tr_b16 v[118:119], v49 offset:1280
    v_mfma_f32_16x16x32_bf16 v[164:167], v[140:143], v[64:67], v[164:167]
    ds_read_b64_tr_b16 v[120:121], v49 offset:32
    ds_read_b64_tr_b16 v[122:123], v49 offset:1312
    v_mfma_f32_16x16x32_bf16 v[168:171], v[144:147], v[64:67], v[168:171]
    ds_read_b64_tr_b16 v[124:125], v49 offset:64
    ds_read_b64_tr_b16 v[126:127], v49 offset:1344
    v_mfma_f32_16x16x32_bf16 v[172:175], v[148:151], v[64:67], v[172:175]
    ds_read_b64_tr_b16 v[128:129], v49 offset:96
    ds_read_b64_tr_b16 v[130:131], v49 offset:1376
    v_mfma_f32_16x16x32_bf16 v[176:179], v[152:155], v[64:67], v[176:179]
    ds_read_b64_tr_b16 v[132:133], v49 offset:128
    ds_read_b64_tr_b16 v[134:135], v49 offset:1408
    buffer_load_dwordx4 v[92:95], v22, s[4:7], s70 offen offset:3072 sc1
    s_waitcnt vmcnt(6)
    s_waitcnt lgkmcnt(10)
    v_mfma_f32_16x16x32_bf16 v[160:163], v[96:99], v[68:71], v[160:163]
    ds_read_b64_tr_b16 v[136:137], v49 offset:5120
    ds_read_b64_tr_b16 v[138:139], v49 offset:6400
    v_mfma_f32_16x16x32_bf16 v[164:167], v[100:103], v[68:71], v[164:167]
    ds_read_b64_tr_b16 v[140:141], v49 offset:5152
    ds_read_b64_tr_b16 v[142:143], v49 offset:6432
    v_mfma_f32_16x16x32_bf16 v[168:171], v[104:107], v[68:71], v[168:171]
    ds_read_b64_tr_b16 v[144:145], v49 offset:5184
    ds_read_b64_tr_b16 v[146:147], v49 offset:6464
    v_mfma_f32_16x16x32_bf16 v[172:175], v[108:111], v[68:71], v[172:175]
    ds_read_b64_tr_b16 v[148:149], v49 offset:5216
    ds_read_b64_tr_b16 v[150:151], v49 offset:6496
    v_mfma_f32_16x16x32_bf16 v[176:179], v[112:115], v[68:71], v[176:179]
    ds_read_b64_tr_b16 v[152:153], v49 offset:5248
    ds_read_b64_tr_b16 v[154:155], v49 offset:6528
    s_add_u32 s70, s70, 4096
    buffer_load_dwordx4 v[64:67], v22, s[4:7], s70 offen offset:0 sc1
    s_waitcnt vmcnt(6)
    s_waitcnt lgkmcnt(10)
    v_mfma_f32_16x16x32_bf16 v[160:163], v[116:119], v[72:75], v[160:163]
    ds_read_b64_tr_b16 v[96:97], v49 offset:10240
    ds_read_b64_tr_b16 v[98:99], v49 offset:11520
    v_mfma_f32_16x16x32_bf16 v[164:167], v[120:123], v[72:75], v[164:167]
    ds_read_b64_tr_b16 v[100:101], v49 offset:10272
    ds_read_b64_tr_b16 v[102:103], v49 offset:11552
    v_mfma_f32_16x16x32_bf16 v[168:171], v[124:127], v[72:75], v[168:171]
    ds_read_b64_tr_b16 v[104:105], v49 offset:10304
    ds_read_b64_tr_b16 v[106:107], v49 offset:11584
    v_mfma_f32_16x16x32_bf16 v[172:175], v[128:131], v[72:75], v[172:175]
    ds_read_b64_tr_b16 v[108:109], v49 offset:10336
    ds_read_b64_tr_b16 v[110:111], v49 offset:11616
    v_mfma_f32_16x16x32_bf16 v[176:179], v[132:135], v[72:75], v[176:179]
    ds_read_b64_tr_b16 v[112:113], v49 offset:10368
    ds_read_b64_tr_b16 v[114:115], v49 offset:11648
    buffer_load_dwordx4 v[68:71], v22, s[4:7], s70 offen offset:1024 sc1
    s_waitcnt vmcnt(6)
    s_waitcnt lgkmcnt(10)
    v_mfma_f32_16x16x32_bf16 v[160:163], v[136:139], v[76:79], v[160:163]
    ds_read_b64_tr_b16 v[116:117], v49 offset:15360
    ds_read_b64_tr_b16 v[118:119], v49 offset:16640
    v_mfma_f32_16x16x32_bf16 v[164:167], v[140:143], v[76:79], v[164:167]
    ds_read_b64_tr_b16 v[120:121], v49 offset:15392
    ds_read_b64_tr_b16 v[122:123], v49 offset:16672
    v_mfma_f32_16x16x32_bf16 v[168:171], v[144:147], v[76:79], v[168:171]
    ds_read_b64_tr_b16 v[124:125], v49 offset:15424
    ds_read_b64_tr_b16 v[126:127], v49 offset:16704
    v_mfma_f32_16x16x32_bf16 v[172:175], v[148:151], v[76:79], v[172:175]
    ds_read_b64_tr_b16 v[128:129], v49 offset:15456
    ds_read_b64_tr_b16 v[130:131], v49 offset:16736
    v_mfma_f32_16x16x32_bf16 v[176:179], v[152:155], v[76:79], v[176:179]
    ds_read_b64_tr_b16 v[132:133], v49 offset:15488
    ds_read_b64_tr_b16 v[134:135], v49 offset:16768
    buffer_load_dwordx4 v[72:75], v22, s[4:7], s70 offen offset:2048 sc1
    s_waitcnt vmcnt(6)
    s_waitcnt lgkmcnt(10)
    v_mfma_f32_16x16x32_bf16 v[160:163], v[96:99], v[80:83], v[160:163]
    ds_read_b64_tr_b16 v[136:137], v49 offset:20480
    ds_read_b64_tr_b16 v[138:139], v49 offset:21760
    v_mfma_f32_16x16x32_bf16 v[164:167], v[100:103], v[80:83], v[164:167]
    ds_read_b64_tr_b16 v[140:141], v49 offset:20512
    ds_read_b64_tr_b16 v[142:143], v49 offset:21792
    v_mfma_f32_16x16x32_bf16 v[168:171], v[104:107], v[80:83], v[168:171]
    ds_read_b64_tr_b16 v[144:145], v49 offset:20544
    ds_read_b64_tr_b16 v[146:147], v49 offset:21824
    v_mfma_f32_16x16x32_bf16 v[172:175], v[108:111], v[80:83], v[172:175]
    ds_read_b64_tr_b16 v[148:149], v49 offset:20576
    ds_read_b64_tr_b16 v[150:151], v49 offset:21856
    v_mfma_f32_16x16x32_bf16 v[176:179], v[112:115], v[80:83], v[176:179]
    ds_read_b64_tr_b16 v[152:153], v49 offset:20608
    ds_read_b64_tr_b16 v[154:155], v49 offset:21888
    buffer_load_dwordx4 v[76:79], v22, s[4:7], s70 offen offset:3072 sc1
    s_waitcnt vmcnt(6)
    s_waitcnt lgkmcnt(10)
    v_mfma_f32_16x16x32_bf16 v[160:163], v[116:119], v[84:87], v[160:163]
    ds_read_b64_tr_b16 v[96:97], v49 offset:25600
    ds_read_b64_tr_b16 v[98:99], v49 offset:26880
    v_mfma_f32_16x16x32_bf16 v[164:167], v[120:123], v[84:87], v[164:167]
    ds_read_b64_tr_b16 v[100:101], v49 offset:25632
    ds_read_b64_tr_b16 v[102:103], v49 offset:26912
    v_mfma_f32_16x16x32_bf16 v[168:171], v[124:127], v[84:87], v[168:171]
    ds_read_b64_tr_b16 v[104:105], v49 offset:25664
    ds_read_b64_tr_b16 v[106:107], v49 offset:26944
    v_mfma_f32_16x16x32_bf16 v[172:175], v[128:131], v[84:87], v[172:175]
    ds_read_b64_tr_b16 v[108:109], v49 offset:25696
    ds_read_b64_tr_b16 v[110:111], v49 offset:26976
    v_mfma_f32_16x16x32_bf16 v[176:179], v[132:135], v[84:87], v[176:179]
    ds_read_b64_tr_b16 v[112:113], v49 offset:25728
    ds_read_b64_tr_b16 v[114:115], v49 offset:27008
    v_cmp_eq_u32 vcc, 1, v50
    s_nop 0
    s_cmp_eq_u32 vcc_lo, -1
    s_cbranch_scc0 Ly_27_spin0
Ly_27_ok:
    v_lshrrev_b32 v52, 3, v1
    v_lshlrev_b32 v52, 12, v52
    v_and_b32 v53, 7, v1
    v_lshl_add_u32 v52, v53, 4, v52
    s_mul_i32 s52, s48, 327680
    s_lshl_b32 s53, s44, 9
    s_add_u32 s52, s52, s53
    s_lshl_b32 s53, s47, 7
    s_add_u32 s52, s52, s53
    s_add_u32 s52, s52, 655360
    s_mul_i32 s53, s46, 3
    s_add_u32 s53, s53, 0
    s_min_u32 s53, s53, 9
    s_lshl_b32 s54, s53, 10
    s_lshl_b32 s55, s49, 14
    s_add_u32 m0, s54, s55
    s_lshl_b32 s53, s53, 15
    s_add_u32 s53, s53, s52
    buffer_load_dwordx4 v52, s[4:7], s53 offen sc1 lds
    s_mul_i32 s53, s46, 3
    s_add_u32 s53, s53, 1
    s_min_u32 s53, s53, 9
    s_lshl_b32 s54, s53, 10
    s_lshl_b32 s55, s49, 14
    s_add_u32 m0, s54, s55
    s_lshl_b32 s53, s53, 15
    s_add_u32 s53, s53, s52
    buffer_load_dwordx4 v52, s[4:7], s53 offen sc1 lds
    s_mul_i32 s53, s46, 3
    s_add_u32 s53, s53, 2
    s_min_u32 s53, s53, 9
    s_lshl_b32 s54, s53, 10
    s_lshl_b32 s55, s49, 14
    s_add_u32 m0, s54, s55
    s_lshl_b32 s53, s53, 15
    s_add_u32 s53, s53, s52
    buffer_load_dwordx4 v52, s[4:7], s53 offen sc1 lds
    s_waitcnt vmcnt(8)
    s_waitcnt lgkmcnt(10)
    v_mfma_f32_16x16x32_bf16 v[160:163], v[136:139], v[88:91], v[160:163]
    ds_read_b64_tr_b16 v[116:117], v49 offset:30720
    ds_read_b64_tr_b16 v[118:119], v49 offset:32000
    v_mfma_f32_16x16x32_bf16 v[164:167], v[140:143], v[88:91], v[164:167]
    ds_read_b64_tr_b16 v[120:121], v49 offset:30752
    ds_read_b64_tr_b16 v[122:123], v49 offset:32032
    v_mfma_f32_16x16x32_bf16 v[168:171], v[144:147], v[88:91], v[168:171]
    ds_read_b64_tr_b16 v[124:125], v49 offset:30784
    ds_read_b64_tr_b16 v[126:127], v49 offset:32064
    v_mfma_f32_16x16x32_bf16 v[172:175], v[148:151], v[88:91], v[172:175]
    ds_read_b64_tr_b16 v[128:129], v49 offset:30816
    ds_read_b64_tr_b16 v[130:131], v49 offset:32096
    v_mfma_f32_16x16x32_bf16 v[176:179], v[152:155], v[88:91], v[176:179]
    ds_read_b64_tr_b16 v[132:133], v49 offset:30848
    ds_read_b64_tr_b16 v[134:135], v49 offset:32128
    s_waitcnt vmcnt(7)
    s_waitcnt lgkmcnt(10)
    v_mfma_f32_16x16x32_bf16 v[160:163], v[96:99], v[92:95], v[160:163]
    ds_read_b64_tr_b16 v[136:137], v49 offset:35840
    ds_read_b64_tr_b16 v[138:139], v49 offset:37120
    v_mfma_f32_16x16x32_bf16 v[164:167], v[100:103], v[92:95], v[164:167]
    ds_read_b64_tr_b16 v[140:141], v49 offset:35872
    ds_read_b64_tr_b16 v[142:143], v49 offset:37152
    v_mfma_f32_16x16x32_bf16 v[168:171], v[104:107], v[92:95], v[168:171]
    ds_read_b64_tr_b16 v[144:145], v49 offset:35904
    ds_read_b64_tr_b16 v[146:147], v49 offset:37184
    v_mfma_f32_16x16x32_bf16 v[172:175], v[108:111], v[92:95], v[172:175]
    ds_read_b64_tr_b16 v[148:149], v49 offset:35936
    ds_read_b64_tr_b16 v[150:151], v49 offset:37216
    v_mfma_f32_16x16x32_bf16 v[176:179], v[112:115], v[92:95], v[176:179]
    ds_read_b64_tr_b16 v[152:153], v49 offset:35968
    ds_read_b64_tr_b16 v[154:155], v49 offset:37248
    s_waitcnt vmcnt(6)
    s_waitcnt lgkmcnt(10)
    v_mfma_f32_16x16x32_bf16 v[160:163], v[116:119], v[64:67], v[160:163]
    ds_read_b64_tr_b16 v[96:97], v49 offset:40960
    ds_read_b64_tr_b16 v[98:99], v49 offset:42240
    v_mfma_f32_16x16x32_bf16 v[164:167], v[120:123], v[64:67], v[164:167]
    ds_read_b64_tr_b16 v[100:101], v49 offset:40992
    ds_read_b64_tr_b16 v[102:103], v49 offset:42272
    v_mfma_f32_16x16x32_bf16 v[168:171], v[124:127], v[64:67], v[168:171]
    ds_read_b64_tr_b16 v[104:105], v49 offset:41024
    ds_read_b64_tr_b16 v[106:107], v49 offset:42304
    v_mfma_f32_16x16x32_bf16 v[172:175], v[128:131], v[64:67], v[172:175]
    ds_read_b64_tr_b16 v[108:109], v49 offset:41056
    ds_read_b64_tr_b16 v[110:111], v49 offset:42336
    v_mfma_f32_16x16x32_bf16 v[176:179], v[132:135], v[64:67], v[176:179]
    ds_read_b64_tr_b16 v[112:113], v49 offset:41088
    ds_read_b64_tr_b16 v[114:115], v49 offset:42368
    s_waitcnt vmcnt(5)
    s_waitcnt lgkmcnt(10)
    v_mfma_f32_16x16x32_bf16 v[160:163], v[136:139], v[68:71], v[160:163]
    ds_read_b64_tr_b16 v[116:117], v49 offset:46080
    ds_read_b64_tr_b16 v[118:119], v49 offset:47360
    v_mfma_f32_16x16x32_bf16 v[164:167], v[140:143], v[68:71], v[164:167]
    ds_read_b64_tr_b16 v[120:121], v49 offset:46112
    ds_read_b64_tr_b16 v[122:123], v49 offset:47392
    v_mfma_f32_16x16x32_bf16 v[168:171], v[144:147], v[68:71], v[168:171]
    ds_read_b64_tr_b16 v[124:125], v49 offset:46144
    ds_read_b64_tr_b16 v[126:127], v49 offset:47424
    v_mfma_f32_16x16x32_bf16 v[172:175], v[148:151], v[68:71], v[172:175]
    ds_read_b64_tr_b16 v[128:129], v49 offset:46176
    ds_read_b64_tr_b16 v[130:131], v49 offset:47456
    v_mfma_f32_16x16x32_bf16 v[176:179], v[152:155], v[68:71], v[176:179]
    ds_read_b64_tr_b16 v[132:133], v49 offset:46208
    ds_read_b64_tr_b16 v[134:135], v49 offset:47488
    s_waitcnt vmcnt(4)
    s_waitcnt lgkmcnt(10)
    v_mfma_f32_16x16x32_bf16 v[160:163], v[96:99], v[72:75], v[160:163]
    v_mfma_f32_16x16x32_bf16 v[164:167], v[100:103], v[72:75], v[164:167]
    v_mfma_f32_16x16x32_bf16 v[168:171], v[104:107], v[72:75], v[168:171]
    v_mfma_f32_16x16x32_bf16 v[172:175], v[108:111], v[72:75], v[172:175]
    v_mfma_f32_16x16x32_bf16 v[176:179], v[112:115], v[72:75], v[176:179]
    s_waitcnt vmcnt(3)
    s_waitcnt lgkmcnt(0)
    v_mfma_f32_16x16x32_bf16 v[160:163], v[116:119], v[76:79], v[160:163]
    v_mfma_f32_16x16x32_bf16 v[164:167], v[120:123], v[76:79], v[164:167]
    v_mfma_f32_16x16x32_bf16 v[168:171], v[124:127], v[76:79], v[168:171]
    v_mfma_f32_16x16x32_bf16 v[172:175], v[128:131], v[76:79], v[172:175]
    v_mfma_f32_16x16x32_bf16 v[176:179], v[132:135], v[76:79], v[176:179]
    v_lshlrev_b32 v52, 16, v2
    v_and_b32 v53, 0xffff0000, v2
    s_nop 1
    v_pk_add_f32 v[52:53], v[52:53], v[160:161]
    v_cvt_pk_bf16_f32 v2, v52, v53
    v_lshlrev_b32 v160, 16, v2
    v_and_b32 v161, 0xffff0000, v2
    v_pk_mul_f32 v[46:47], v[160:161], v[160:161]
    v_mov_b32 v44, v160
    v_mov_b32 v45, v161
    v_lshlrev_b32 v52, 16, v3
    v_and_b32 v53, 0xffff0000, v3
    v_pk_add_f32 v[52:53], v[52:53], v[162:163]
    v_cvt_pk_bf16_f32 v3, v52, v53
    v_lshlrev_b32 v162, 16, v3
    v_and_b32 v163, 0xffff0000, v3
    v_pk_add_f32 v[44:45], v[44:45], v[162:163]
    v_pk_fma_f32 v[46:47], v[162:163], v[162:163], v[46:47]
    v_lshlrev_b32 v52, 16, v4
    v_and_b32 v53, 0xffff0000, v4
    v_pk_add_f32 v[52:53], v[52:53], v[164:165]
    v_cvt_pk_bf16_f32 v4, v52, v53
    v_lshlrev_b32 v164, 16, v4
    v_and_b32 v165, 0xffff0000, v4
    v_pk_add_f32 v[44:45], v[44:45], v[164:165]
    v_pk_fma_f32 v[46:47], v[164:165], v[164:165], v[46:47]
    v_lshlrev_b32 v52, 16, v5
    v_and_b32 v53, 0xffff0000, v5
    v_pk_add_f32 v[52:53], v[52:53], v[166:167]
    v_cvt_pk_bf16_f32 v5, v52, v53
    v_lshlrev_b32 v166, 16, v5
    v_and_b32 v167, 0xffff0000, v5
    v_pk_add_f32 v[44:45], v[44:45], v[166:167]
    v_pk_fma_f32 v[46:47], v[166:167], v[166:167], v[46:47]
    v_lshlrev_b32 v52, 16, v6
    v_and_b32 v53, 0xffff0000, v6
    v_pk_add_f32 v[52:53], v[52:53], v[168:169]
    v_cvt_pk_bf16_f32 v6, v52, v53
    v_lshlrev_b32 v168, 16, v6
    v_and_b32 v169, 0xffff0000, v6
    v_pk_add_f32 v[44:45], v[44:45], v[168:169]
    v_pk_fma_f32 v[46:47], v[168:169], v[168:169], v[46:47]
    v_lshlrev_b32 v52, 16, v7
    v_and_b32 v53, 0xffff0000, v7
    v_pk_add_f32 v[52:53], v[52:53], v[170:171]
    v_cvt_pk_bf16_f32 v7, v52, v53
    v_lshlrev_b32 v170, 16, v7
    v_and_b32 v171, 0xffff0000, v7
    v_pk_add_f32 v[44:45], v[44:45], v[170:171]
    v_pk_fma_f32 v[46:47], v[170:171], v[170:171], v[46:47]
    v_lshlrev_b32 v52, 16, v8
    v_and_b32 v53, 0xffff0000, v8
    v_pk_add_f32 v[52:53], v[52:53], v[172:173]
    v_cvt_pk_bf16_f32 v8, v52, v53
    v_lshlrev_b32 v172, 16, v8
    v_and_b32 v173, 0xffff0000, v8
    v_pk_add_f32 v[44:45], v[44:45], v[172:173]
    v_pk_fma_f32 v[46:47], v[172:173], v[172:173], v[46:47]
    v_lshlrev_b32 v52, 16, v9
    v_and_b32 v53, 0xffff0000, v9
    v_pk_add_f32 v[52:53], v[52:53], v[174:175]
    v_cvt_pk_bf16_f32 v9, v52, v53
    v_lshlrev_b32 v174, 16, v9
    v_and_b32 v175, 0xffff0000, v9
    v_pk_add_f32 v[44:45], v[44:45], v[174:175]
    v_pk_fma_f32 v[46:47], v[174:175], v[174:175], v[46:47]
    v_lshlrev_b32 v52, 16, v10
    v_and_b32 v53, 0xffff0000, v10
    v_pk_add_f32 v[52:53], v[52:53], v[176:177]
    v_cvt_pk_bf16_f32 v10, v52, v53
    v_lshlrev_b32 v176, 16, v10
    v_and_b32 v177, 0xffff0000, v10
    v_pk_add_f32 v[44:45], v[44:45], v[176:177]
    v_pk_fma_f32 v[46:47], v[176:177], v[176:177], v[46:47]
    v_lshlrev_b32 v52, 16, v11
    v_and_b32 v53, 0xffff0000, v11
    v_pk_add_f32 v[52:53], v[52:53], v[178:179]
    v_cvt_pk_bf16_f32 v11, v52, v53
    v_lshlrev_b32 v178, 16, v11
    v_and_b32 v179, 0xffff0000, v11
    v_pk_add_f32 v[44:45], v[44:45], v[178:179]
    v_pk_fma_f32 v[46:47], v[178:179], v[178:179], v[46:47]
    v_add_f32 v44, v44, v45
    v_add_f32 v45, v46, v47
    v_mov_b32 v52, v44
    v_mov_b32 v53, v45
    s_nop 0
    v_permlane16_swap_b32 v52, v44
    v_permlane16_swap_b32 v53, v45
    v_add_f32 v44, v44, v52
    v_add_f32 v45, v45, v53
    v_mov_b32 v52, v44
    v_mov_b32 v53, v45
    s_nop 0
    v_permlane32_swap_b32 v52, v44
    v_permlane32_swap_b32 v53, v45
    v_add_f32 v44, v44, v52
    v_add_f32 v45, v45, v53
    s_add_u32 s52, s3, 131072
    s_lshl_b32 s53, s49, 18
    s_add_u32 s52, s52, s53
    s_mov_b64 exec, 0xffff
    buffer_store_dwordx2 v[44:45], v22, s[4:7], s52 offen
    s_mov_b64 exec, -1
    s_add_u32 s95, s95, 1
    s_cmp_eq_u32 s50, 1
    s_cbranch_scc0 Lxs_28_slow
    s_mov_b32 s66, 0x40000
Lxs_28_poll:
    buffer_load_dwordx4 v[48:51], v56, s[4:7], s72 offen sc1
    s_waitcnt vmcnt(0)
    v_max3_u32 v44, v48, v49, v50
    v_max_u32 v44, v44, v51
    v_cmp_eq_u32 vcc, -1, v44
    s_nop 0
    s_cmp_eq_u64 vcc, 0
    s_cbranch_scc0 Lxs_28_retry
Lxs_28_have:
    s_cmp_eq_u32 s49, 0
    s_cbranch_scc0 Ly_27_nopack
    s_barrier
    v_lshrrev_b32 v44, 4, v1
    v_bfe_u32 v45, v1, 2, 2
    v_lshl_add_u32 v44, v44, 2, v45
    v_lshlrev_b32 v44, 7, v44
    v_and_b32 v45, 3, v1
    v_lshl_add_u32 v44, v45, 3, v44
    s_lshl_b32 s52, s46, 5
    v_add_u32 v44, s52, v44
    ds_read_b64_tr_b16 v[12:13], v44 offset:0
    ds_read_b64_tr_b16 v[14:15], v44 offset:2048
    ds_read_b64_tr_b16 v[16:17], v44 offset:4096
    ds_read_b64_tr_b16 v[18:19], v44 offset:6144
    ds_read_b64_tr_b16 v[20:21], v44 offset:8192
    s_waitcnt lgkmcnt(0)
Ly_27_nopack:
    v_add_f32 v48, v48, v50
    v_add_f32 v49, v49, v51
    v_mov_b32 v44, v48
    v_mov_b32 v45, v49
    s_nop 0
    v_permlane16_swap_b32 v44, v48
    v_permlane16_swap_b32 v45, v49
    v_add_f32 v48, v48, v44
    v_add_f32 v49, v49, v45
    v_mov_b32 v44, v48
    v_mov_b32 v45, v49
    s_nop 0
    v_permlane32_swap_b32 v44, v48
    v_permlane32_swap_b32 v45, v49
    v_add_f32 v48, v48, v44
    v_add_f32 v49, v49, v45
    v_mul_f32 v48, 0x3acccccd, v48
    v_mul_f32 v49, 0x3acccccd, v49
    v_fma_f32 v49, -v48, v48, v49
    v_max_f32 v49, 0, v49
    v_add_f32 v49, 0x3727c5ac, v49
    v_rsq_f32 v54, v49
    v_sub_f32 v52, 0, v48
    v_lshlrev_b32 v44, 16, v12
    v_and_b32 v45, 0xffff0000, v12
    v_pk_add_f32 v[48:49], v[160:161], v[52:53] op_sel_hi:[1,0]
    s_nop 0
    v_pk_mul_f32 v[48:49], v[48:49], v[54:55] op_sel_hi:[1,0]
    s_nop 0
    v_pk_fma_f32 v[48:49], v[48:49], v[44:45], v[160:161]
    v_cvt_pk_bf16_f32 v2, v48, v49
    v_lshlrev_b32 v44, 16, v13
    v_and_b32 v45, 0xffff0000, v13
    v_pk_add_f32 v[48:49], v[162:163], v[52:53] op_sel_hi:[1,0]
    s_nop 0
    v_pk_mul_f32 v[48:49], v[48:49], v[54:55] op_sel_hi:[1,0]
    s_nop 0
    v_pk_fma_f32 v[48:49], v[48:49], v[44:45], v[162:163]
    v_cvt_pk_bf16_f32 v3, v48, v49
    v_lshlrev_b32 v44, 16, v14
    v_and_b32 v45, 0xffff0000, v14
    v_pk_add_f32 v[48:49], v[164:165], v[52:53] op_sel_hi:[1,0]
    s_nop 0
    v_pk_mul_f32 v[48:49], v[48:49], v[54:55] op_sel_hi:[1,0]
    s_nop 0
    v_pk_fma_f32 v[48:49], v[48:49], v[44:45], v[164:165]
    v_cvt_pk_bf16_f32 v4, v48, v49
    v_lshlrev_b32 v44, 16, v15
    v_and_b32 v45, 0xffff0000, v15
    v_pk_add_f32 v[48:49], v[166:167], v[52:53] op_sel_hi:[1,0]
    s_nop 0
    v_pk_mul_f32 v[48:49], v[48:49], v[54:55] op_sel_hi:[1,0]
    s_nop 0
    v_pk_fma_f32 v[48:49], v[48:49], v[44:45], v[166:167]
    v_cvt_pk_bf16_f32 v5, v48, v49
    v_lshlrev_b32 v44, 16, v16
    v_and_b32 v45, 0xffff0000, v16
    v_pk_add_f32 v[48:49], v[168:169], v[52:53] op_sel_hi:[1,0]
    s_nop 0
    v_pk_mul_f32 v[48:49], v[48:49], v[54:55] op_sel_hi:[1,0]
    s_nop 0
    v_pk_fma_f32 v[48:49], v[48:49], v[44:45], v[168:169]
    v_cvt_pk_bf16_f32 v6, v48, v49
    v_lshlrev_b32 v44, 16, v17
    v_and_b32 v45, 0xffff0000, v17
    v_pk_add_f32 v[48:49], v[170:171], v[52:53] op_sel_hi:[1,0]
    s_nop 0
    v_pk_mul_f32 v[48:49], v[48:49], v[54:55] op_sel_hi:[1,0]
    s_nop 0
    v_pk_fma_f32 v[48:49], v[48:49], v[44:45], v[170:171]
    v_cvt_pk_bf16_f32 v7, v48, v49
    v_lshlrev_b32 v44, 16, v18
    v_and_b32 v45, 0xffff0000, v18
    v_pk_add_f32 v[48:49], v[172:173], v[52:53] op_sel_hi:[1,0]
    s_nop 0
    v_pk_mul_f32 v[48:49], v[48:49], v[54:55] op_sel_hi:[1,0]
    s_nop 0
    v_pk_fma_f32 v[48:49], v[48:49], v[44:45], v[172:173]
    v_cvt_pk_bf16_f32 v8, v48, v49
    v_lshlrev_b32 v44, 16, v19
    v_and_b32 v45, 0xffff0000, v19
    v_pk_add_f32 v[48:49], v[174:175], v[52:53] op_sel_hi:[1,0]
    s_nop 0
    v_pk_mul_f32 v[48:49], v[48:49], v[54:55] op_sel_hi:[1,0]
    s_nop 0
    v_pk_fma_f32 v[48:49], v[48:49], v[44:45], v[174:175]
    v_cvt_pk_bf16_f32 v9, v48, v49
    v_lshlrev_b32 v44, 16, v20
    v_and_b32 v45, 0xffff0000, v20
    v_pk_add_f32 v[48:49], v[176:177], v[52:53] op_sel_hi:[1,0]
    s_nop 0
    v_pk_mul_f32 v[48:49], v[48:49], v[54:55] op_sel_hi:[1,0]
    s_nop 0
    v_pk_fma_f32 v[48:49], v[48:49], v[44:45], v[176:177]
    v_cvt_pk_bf16_f32 v10, v48, v49
    v_lshlrev_b32 v44, 16, v21
    v_and_b32 v45, 0xffff0000, v21
    v_pk_add_f32 v[48:49], v[178:179], v[52:53] op_sel_hi:[1,0]
    s_nop 0
    v_pk_mul_f32 v[48:49], v[48:49], v[54:55] op_sel_hi:[1,0]
    s_nop 0
    v_pk_fma_f32 v[48:49], v[48:49], v[44:45], v[178:179]
    v_cvt_pk_bf16_f32 v11, v48, v49
    s_cmp_eq_u32 s49, 0
    s_cbranch_scc0 L_final
    s_add_u32 s53, s63, 4096
    buffer_store_dwordx2 v[2:3], v57, s[4:7], s63 offen offset:0
    buffer_store_dwordx2 v[4:5], v57, s[4:7], s63 offen offset:1024
    buffer_store_dwordx2 v[6:7], v57, s[4:7], s63 offen offset:2048
    buffer_store_dwordx2 v[8:9], v57, s[4:7], s63 offen offset:3072
    buffer_store_dwordx2 v[10:11], v57, s[4:7], s53 offen
    v_lshlrev_b32 v48, 16, v2
    v_and_b32 v49, 0xffff0000, v2
    v_pk_mul_f32 v[52:53], v[48:49], v[48:49]
    v_mov_b32 v50, v48
    v_mov_b32 v51, v49
    v_lshlrev_b32 v48, 16, v3
    v_and_b32 v49, 0xffff0000, v3
    v_pk_add_f32 v[50:51], v[50:51], v[48:49]
    v_pk_fma_f32 v[52:53], v[48:49], v[48:49], v[52:53]
    v_lshlrev_b32 v48, 16, v4
    v_and_b32 v49, 0xffff0000, v4
    v_pk_add_f32 v[50:51], v[50:51], v[48:49]
    v_pk_fma_f32 v[52:53], v[48:49], v[48:49], v[52:53]
    v_lshlrev_b32 v48, 16, v5
    v_and_b32 v49, 0xffff0000, v5
    v_pk_add_f32 v[50:51], v[50:51], v[48:49]
    v_pk_fma_f32 v[52:53], v[48:49], v[48:49], v[52:53]
    v_lshlrev_b32 v48, 16, v6
    v_and_b32 v49, 0xffff0000, v6
    v_pk_add_f32 v[50:51], v[50:51], v[48:49]
    v_pk_fma_f32 v[52:53], v[48:49], v[48:49], v[52:53]
    v_lshlrev_b32 v48, 16, v7
    v_and_b32 v49, 0xffff0000, v7
    v_pk_add_f32 v[50:51], v[50:51], v[48:49]
    v_pk_fma_f32 v[52:53], v[48:49], v[48:49], v[52:53]
    v_lshlrev_b32 v48, 16, v8
    v_and_b32 v49, 0xffff0000, v8
    v_pk_add_f32 v[50:51], v[50:51], v[48:49]
    v_pk_fma_f32 v[52:53], v[48:49], v[48:49], v[52:53]
    v_lshlrev_b32 v48, 16, v9
    v_and_b32 v49, 0xffff0000, v9
    v_pk_add_f32 v[50:51], v[50:51], v[48:49]
    v_pk_fma_f32 v[52:53], v[48:49], v[48:49], v[52:53]
    v_lshlrev_b32 v48, 16, v10
    v_and_b32 v49, 0xffff0000, v10
    v_pk_add_f32 v[50:51], v[50:51], v[48:49]
    v_pk_fma_f32 v[52:53], v[48:49], v[48:49], v[52:53]
    v_lshlrev_b32 v48, 16, v11
    v_and_b32 v49, 0xffff0000, v11
    v_pk_add_f32 v[50:51], v[50:51], v[48:49]
    v_pk_fma_f32 v[52:53], v[48:49], v[48:49], v[52:53]
    v_add_f32 v46, v50, v51
    v_add_f32 v47, v52, v53
    v_mov_b32 v48, v46
    v_mov_b32 v49, v47
    s_nop 0
    v_permlane16_swap_b32 v48, v46
    v_permlane16_swap_b32 v49, v47
    v_add_f32 v46, v46, v48
    v_add_f32 v47, v47, v49
    v_mov_b32 v48, v46
    v_mov_b32 v49, v47
    s_nop 0
    v_permlane32_swap_b32 v48, v46
    v_permlane32_swap_b32 v49, v47
    v_add_f32 v46, v46, v48
    v_add_f32 v47, v47, v49
    s_add_u32 s52, s3, 262144
    s_mov_b64 exec, 0xffff
    buffer_store_dwordx2 v[46:47], v22, s[4:7], s52 offen
    s_mov_b64 exec, -1
    v_mov_b32 v44, 5
    s_cmp_eq_u32 s46, 0
    s_waitcnt vmcnt(0)
    s_barrier
    s_cbranch_scc0 Lsg_29
    s_mov_b64 exec, 1
    s_cmp_eq_u32 s50, 1
    s_cbranch_scc0 Lsig_30_slow
    buffer_store_dword v44, v22, s[4:7], s67 offen
Lsig_30_done:
    s_mov_b64 exec, -1
Lsg_29:
    s_mov_b32 s66, 0x40000
Lwl_31:
    buffer_load_dword v44, v0, s[4:7], s64 offen sc1
    s_waitcnt vmcnt(0)
    v_cmp_le_u32 vcc, 5, v44
    s_nop 0
    s_cmp_eq_u32 vcc_lo, -1
    s_cbranch_scc0 Lwl_31_retry
Lwl_31_ok:
    s_cmp_eq_u32 s50, 1
    s_cbranch_scc0 Lwl_31_inv
Lwl_31_fin:
    s_add_u32 s52, s51, 4521984
    s_mul_i32 s53, s46, 40960
    s_add_u32 s70, s52, s53
    s_add_u32 s52, s52, 286720
    s_sub_u32 s71, s52, s53
    buffer_load_dwordx4 v[128:131], v22, s[4:7], s70 offen offset:0 sc1
    buffer_load_dwordx4 v[132:135], v22, s[4:7], s71 offen offset:0 sc1
    buffer_load_dwordx4 v[136:139], v22, s[4:7], s70 offen offset:1024 sc1
    buffer_load_dwordx4 v[140:143], v22, s[4:7], s71 offen offset:1024 sc1
    buffer_load_dwordx4 v[144:147], v22, s[4:7], s70 offen offset:2048 sc1
    buffer_load_dwordx4 v[148:151], v22, s[4:7], s71 offen offset:2048 sc1
    buffer_load_dwordx4 v[152:155], v22, s[4:7], s70 offen offset:3072 sc1
    buffer_load_dwordx4 v[156:159], v22, s[4:7], s71 offen offset:3072 sc1
    s_add_u32 s70, s70, 4096
    buffer_load_dwordx4 v[160:163], v22, s[4:7], s70 offen offset:0 sc1
    s_add_u32 s71, s71, 4096
    buffer_load_dwordx4 v[164:167], v22, s[4:7], s71 offen offset:0 sc1
    s_waitcnt vmcnt(8)
    v_mfma_f32_32x32x16_bf16 v[64:79], a[0:3], v[128:131], 0
    v_mfma_f32_32x32x16_bf16 v[80:95], a[4:7], v[128:131], 0
    v_mfma_f32_32x32x16_bf16 v[96:111], a[0:3], v[132:135], 0
    v_mfma_f32_32x32x16_bf16 v[112:127], a[4:7], v[132:135], 0
    buffer_load_dwordx4 v[128:131], v22, s[4:7], s70 offen offset:1024 sc1
    s_waitcnt vmcnt(7)
    v_mfma_f32_32x32x16_bf16 v[64:79], a[8:11], v[136:139], v[64:79]
    v_mfma_f32_32x32x16_bf16 v[80:95], a[12:15], v[136:139], v[80:95]
    buffer_load_dwordx4 v[132:135], v22, s[4:7], s71 offen offset:1024 sc1
    v_mfma_f32_32x32x16_bf16 v[96:111], a[8:11], v[140:143], v[96:111]
    v_mfma_f32_32x32x16_bf16 v[112:127], a[12:15], v[140:143], v[112:127]
    buffer_load_dwordx4 v[136:139], v22, s[4:7], s70 offen offset:2048 sc1
    s_waitcnt vmcnt(7)
    v_mfma_f32_32x32x16_bf16 v[64:79], a[16:19], v[144:147], v[64:79]
    v_mfma_f32_32x32x16_bf16 v[80:95], a[20:23], v[144:147], v[80:95]
    buffer_load_dwordx4 v[140:143], v22, s[4:7], s71 offen offset:2048 sc1
    v_mfma_f32_32x32x16_bf16 v[96:111], a[16:19], v[148:151], v[96:111]
    v_mfma_f32_32x32x16_bf16 v[112:127], a[20:23], v[148:151], v[112:127]
    buffer_load_dwordx4 v[144:147], v22, s[4:7], s70 offen offset:3072 sc1
    s_waitcnt vmcnt(7)
    v_mfma_f32_32x32x16_bf16 v[64:79], a[24:27], v[152:155], v[64:79]
    v_mfma_f32_32x32x16_bf16 v[80:95], a[28:31], v[152:155], v[80:95]
    buffer_load_dwordx4 v[148:151], v22, s[4:7], s71 offen offset:3072 sc1
    v_mfma_f32_32x32x16_bf16 v[96:111], a[24:27], v[156:159], v[96:111]
    v_mfma_f32_32x32x16_bf16 v[112:127], a[28:31], v[156:159], v[112:127]
    s_add_u32 s70, s70, 4096
    buffer_load_dwordx4 v[152:155], v22, s[4:7], s70 offen offset:0 sc1
    s_waitcnt vmcnt(7)
    v_mfma_f32_32x32x16_bf16 v[64:79], a[32:35], v[160:163], v[64:79]
    v_mfma_f32_32x32x16_bf16 v[80:95], a[36:39], v[160:163], v[80:95]
    s_add_u32 s71, s71, 4096
    buffer_load_dwordx4 v[156:159], v22, s[4:7], s71 offen offset:0 sc1
    v_mfma_f32_32x32x16_bf16 v[96:111], a[32:35], v[164:167], v[96:111]
    v_mfma_f32_32x32x16_bf16 v[112:127], a[36:39], v[164:167], v[112:127]
    buffer_load_dwordx4 v[160:163], v22, s[4:7], s70 offen offset:1024 sc1
    s_waitcnt vmcnt(7)
    v_mfma_f32_32x32x16_bf16 v[64:79], a[40:43], v[128:131], v[64:79]
    v_mfma_f32_32x32x16_bf16 v[80:95], a[44:47], v[128:131], v[80:95]
    buffer_load_dwordx4 v[164:167], v22, s[4:7], s71 offen offset:1024 sc1
    v_mfma_f32_32x32x16_bf16 v[96:111], a[40:43], v[132:135], v[96:111]
    v_mfma_f32_32x32x16_bf16 v[112:127], a[44:47], v[132:135], v[112:127]
    buffer_load_dwordx4 v[128:131], v22, s[4:7], s70 offen offset:2048 sc1
    s_waitcnt vmcnt(7)
    v_mfma_f32_32x32x16_bf16 v[64:79], a[48:51], v[136:139], v[64:79]
    v_mfma_f32_32x32x16_bf16 v[80:95], a[52:55], v[136:139], v[80:95]
    buffer_load_dwordx4 v[132:135], v22, s[4:7], s71 offen offset:2048 sc1
    v_mfma_f32_32x32x16_bf16 v[96:111], a[48:51], v[140:143], v[96:111]
    v_mfma_f32_32x32x16_bf16 v[112:127], a[52:55], v[140:143], v[112:127]
    buffer_load_dwordx4 v[136:139], v22, s[4:7], s70 offen offset:3072 sc1
    s_waitcnt vmcnt(7)
    v_mfma_f32_32x32x16_bf16 v[64:79], a[56:59], v[144:147], v[64:79]
    v_mfma_f32_32x32x16_bf16 v[80:95], a[60:63], v[144:147], v[80:95]
    buffer_load_dwordx4 v[140:143], v22, s[4:7], s71 offen offset:3072 sc1
    v_mfma_f32_32x32x16_bf16 v[96:111], a[56:59], v[148:151], v[96:111]
    v_mfma_f32_32x32x16_bf16 v[112:127], a[60:63], v[148:151], v[112:127]
    s_add_u32 s70, s70, 4096
    buffer_load_dwordx4 v[144:147], v22, s[4:7], s70 offen offset:0 sc1
    s_waitcnt vmcnt(7)
    v_mfma_f32_32x32x16_bf16 v[64:79], a[64:67], v[152:155], v[64:79]
    v_mfma_f32_32x32x16_bf16 v[80:95], a[68:71], v[152:155], v[80:95]
    s_add_u32 s71, s71, 4096
    buffer_load_dwordx4 v[148:151], v22, s[4:7], s71 offen offset:0 sc1
    v_mfma_f32_32x32x16_bf16 v[96:111], a[64:67], v[156:159], v[96:111]
    v_mfma_f32_32x32x16_bf16 v[112:127], a[68:71], v[156:159], v[112:127]
    buffer_load_dwordx4 v[152:155], v22, s[4:7], s70 offen offset:1024 sc1
    s_waitcnt vmcnt(7)
    v_mfma_f32_32x32x16_bf16 v[64:79], a[72:75], v[160:163], v[64:79]
    v_mfma_f32_32x32x16_bf16 v[80:95], a[76:79], v[160:163], v[80:95]
    buffer_load_dwordx4 v[156:159], v22, s[4:7], s71 offen offset:1024 sc1
    v_mfma_f32_32x32x16_bf16 v[96:111], a[72:75], v[164:167], v[96:111]
    v_mfma_f32_32x32x16_bf16 v[112:127], a[76:79], v[164:167], v[112:127]
    buffer_load_dwordx4 v[160:163], v22, s[4:7], s70 offen offset:2048 sc1
    s_waitcnt vmcnt(7)
    v_mfma_f32_32x32x16_bf16 v[64:79], a[80:83], v[128:131], v[64:79]
    v_mfma_f32_32x32x16_bf16 v[80:95], a[84:87], v[128:131], v[80:95]
    buffer_load_dwordx4 v[164:167], v22, s[4:7], s71 offen offset:2048 sc1
    v_mfma_f32_32x32x16_bf16 v[96:111], a[80:83], v[132:135], v[96:111]
    v_mfma_f32_32x32x16_bf16 v[112:127], a[84:87], v[132:135], v[112:127]
    buffer_load_dwordx4 v[128:131], v22, s[4:7], s70 offen offset:3072 sc1
    s_waitcnt vmcnt(7)
    v_mfma_f32_32x32x16_bf16 v[64:79], a[88:91], v[136:139], v[64:79]
    v_mfma_f32_32x32x16_bf16 v[80:95], a[92:95], v[136:139], v[80:95]
    buffer_load_dwordx4 v[132:135], v22, s[4:7], s71 offen offset:3072 sc1
    v_mfma_f32_32x32x16_bf16 v[96:111], a[88:91], v[140:143], v[96:111]
    v_mfma_f32_32x32x16_bf16 v[112:127], a[92:95], v[140:143], v[112:127]
    s_add_u32 s70, s70, 4096
    buffer_load_dwordx4 v[136:139], v22, s[4:7], s70 offen offset:0 sc1
    s_waitcnt vmcnt(7)
    v_mfma_f32_32x32x16_bf16 v[64:79], a[96:99], v[144:147], v[64:79]
    v_mfma_f32_32x32x16_bf16 v[80:95], a[100:103], v[144:147], v[80:95]
    s_add_u32 s71, s71, 4096
    buffer_load_dwordx4 v[140:143], v22, s[4:7], s71 offen offset:0 sc1
    v_mfma_f32_32x32x16_bf16 v[96:111], a[96:99], v[148:151], v[96:111]
    v_mfma_f32_32x32x16_bf16 v[112:127], a[100:103], v[148:151], v[112:127]
    buffer_load_dwordx4 v[144:147], v22, s[4:7], s70 offen offset:1024 sc1
    s_waitcnt vmcnt(7)
    v_mfma_f32_32x32x16_bf16 v[64:79], a[104:107], v[152:155], v[64:79]
    v_mfma_f32_32x32x16_bf16 v[80:95], a[108:111], v[152:155], v[80:95]
    buffer_load_dwordx4 v[148:151], v22, s[4:7], s71 offen offset:1024 sc1
    v_mfma_f32_32x32x16_bf16 v[96:111], a[104:107], v[156:159], v[96:111]
    v_mfma_f32_32x32x16_bf16 v[112:127], a[108:111], v[156:159], v[112:127]
    buffer_load_dwordx4 v[152:155], v22, s[4:7], s70 offen offset:2048 sc1
    s_waitcnt vmcnt(7)
    v_mfma_f32_32x32x16_bf16 v[64:79], a[112:115], v[160:163], v[64:79]
    v_mfma_f32_32x32x16_bf16 v[80:95], a[116:119], v[160:163], v[80:95]
    buffer_load_dwordx4 v[156:159], v22, s[4:7], s71 offen offset:2048 sc1
    v_mfma_f32_32x32x16_bf16 v[96:111], a[112:115], v[164:167], v[96:111]
    v_mfma_f32_32x32x16_bf16 v[112:127], a[116:119], v[164:167], v[112:127]
    buffer_load_dwordx4 v[160:163], v22, s[4:7], s70 offen offset:3072 sc1
    s_waitcnt vmcnt(7)
    v_mfma_f32_32x32x16_bf16 v[64:79], a[120:123], v[128:131], v[64:79]
    v_mfma_f32_32x32x16_bf16 v[80:95], a[124:127], v[128:131], v[80:95]
    buffer_load_dwordx4 v[164:167], v22, s[4:7], s71 offen offset:3072 sc1
    v_mfma_f32_32x32x16_bf16 v[96:111], a[120:123], v[132:135], v[96:111]
    v_mfma_f32_32x32x16_bf16 v[112:127], a[124:127], v[132:135], v[112:127]
    s_add_u32 s70, s70, 4096
    buffer_load_dwordx4 v[128:131], v22, s[4:7], s70 offen offset:0 sc1
    s_waitcnt vmcnt(7)
    v_mfma_f32_32x32x16_bf16 v[64:79], a[128:131], v[136:139], v[64:79]
    v_mfma_f32_32x32x16_bf16 v[80:95], a[132:135], v[136:139], v[80:95]
    s_add_u32 s71, s71, 4096
    buffer_load_dwordx4 v[132:135], v22, s[4:7], s71 offen offset:0 sc1
    v_mfma_f32_32x32x16_bf16 v[96:111], a[128:131], v[140:143], v[96:111]
    v_mfma_f32_32x32x16_bf16 v[112:127], a[132:135], v[140:143], v[112:127]
    buffer_load_dwordx4 v[136:139], v22, s[4:7], s70 offen offset:1024 sc1
    s_waitcnt vmcnt(7)
    v_mfma_f32_32x32x16_bf16 v[64:79], a[136:139], v[144:147], v[64:79]
    v_mfma_f32_32x32x16_bf16 v[80:95], a[140:143], v[144:147], v[80:95]
    buffer_load_dwordx4 v[140:143], v22, s[4:7], s71 offen offset:1024 sc1
    v_mfma_f32_32x32x16_bf16 v[96:111], a[136:139], v[148:151], v[96:111]
    v_mfma_f32_32x32x16_bf16 v[112:127], a[140:143], v[148:151], v[112:127]
    buffer_load_dwordx4 v[144:147], v22, s[4:7], s70 offen offset:2048 sc1
    s_waitcnt vmcnt(7)
    v_mfma_f32_32x32x16_bf16 v[64:79], a[144:147], v[152:155], v[64:79]
    v_mfma_f32_32x32x16_bf16 v[80:95], a[148:151], v[152:155], v[80:95]
    buffer_load_dwordx4 v[148:151], v22, s[4:7], s71 offen offset:2048 sc1
    v_mfma_f32_32x32x16_bf16 v[96:111], a[144:147], v[156:159], v[96:111]
    v_mfma_f32_32x32x16_bf16 v[112:127], a[148:151], v[156:159], v[112:127]
    buffer_load_dwordx4 v[152:155], v22, s[4:7], s70 offen offset:3072 sc1
    s_waitcnt vmcnt(7)
    v_mfma_f32_32x32x16_bf16 v[64:79], a[152:155], v[160:163], v[64:79]
    v_mfma_f32_32x32x16_bf16 v[80:95], a[156:159], v[160:163], v[80:95]
    buffer_load_dwordx4 v[156:159], v22, s[4:7], s71 offen offset:3072 sc1
    v_mfma_f32_32x32x16_bf16 v[96:111], a[152:155], v[164:167], v[96:111]
    v_mfma_f32_32x32x16_bf16 v[112:127], a[156:159], v[164:167], v[112:127]
    s_add_u32 s70, s70, 4096
    buffer_load_dwordx4 v[160:163], v22, s[4:7], s70 offen offset:0 sc1
    s_waitcnt vmcnt(7)
    v_mfma_f32_32x32x16_bf16 v[64:79], a[160:163], v[128:131], v[64:79]
    v_mfma_f32_32x32x16_bf16 v[80:95], a[164:167], v[128:131], v[80:95]
    s_add_u32 s71, s71, 4096
    buffer_load_dwordx4 v[164:167], v22, s[4:7], s71 offen offset:0 sc1
    v_mfma_f32_32x32x16_bf16 v[96:111], a[160:163], v[132:135], v[96:111]
    v_mfma_f32_32x32x16_bf16 v[112:127], a[164:167], v[132:135], v[112:127]
    buffer_load_dwordx4 v[128:131], v22, s[4:7], s70 offen offset:1024 sc1
    s_lshl_b32 s52, s44, 14
    s_add_u32 s52, s52, 393216
    s_lshl_b32 s53, s46, 11
    s_add_u32 s54, s52, s53
    s_add_u32 s52, s52, 14336
    s_sub_u32 s55, s52, s53
    buffer_load_dwordx4 v[44:47], v22, s[4:7], s54 offen sc1
    buffer_load_dwordx4 v[48:51], v22, s[4:7], s54 offen offset:1024 sc1
    buffer_load_dwordx4 v[52:55], v22, s[4:7], s55 offen sc1
    buffer_load_dwordx4 v[56:59], v22, s[4:7], s55 offen offset:1024 sc1
    s_waitcnt vmcnt(11)
    v_mfma_f32_32x32x16_bf16 v[64:79], a[168:171], v[136:139], v[64:79]
    v_mfma_f32_32x32x16_bf16 v[80:95], a[172:175], v[136:139], v[80:95]
    buffer_load_dwordx4 v[132:135], v22, s[4:7], s71 offen offset:1024 sc1
    v_mfma_f32_32x32x16_bf16 v[96:111], a[168:171], v[140:143], v[96:111]
    v_mfma_f32_32x32x16_bf16 v[112:127], a[172:175], v[140:143], v[112:127]
    buffer_load_dwordx4 v[136:139], v22, s[4:7], s70 offen offset:2048 sc1
    s_waitcnt vmcnt(11)
    v_mfma_f32_32x32x16_bf16 v[64:79], a[176:179], v[144:147], v[64:79]
    v_mfma_f32_32x32x16_bf16 v[80:95], a[180:183], v[144:147], v[80:95]
    buffer_load_dwordx4 v[140:143], v22, s[4:7], s71 offen offset:2048 sc1
    v_mfma_f32_32x32x16_bf16 v[96:111], a[176:179], v[148:151], v[96:111]
    v_mfma_f32_32x32x16_bf16 v[112:127], a[180:183], v[148:151], v[112:127]
    buffer_load_dwordx4 v[144:147], v22, s[4:7], s70 offen offset:3072 sc1
    s_waitcnt vmcnt(11)
    v_mfma_f32_32x32x16_bf16 v[64:79], a[184:187], v[152:155], v[64:79]
    v_mfma_f32_32x32x16_bf16 v[80:95], a[188:191], v[152:155], v[80:95]
    buffer_load_dwordx4 v[148:151], v22, s[4:7], s71 offen offset:3072 sc1
    v_mfma_f32_32x32x16_bf16 v[96:111], a[184:187], v[156:159], v[96:111]
    v_mfma_f32_32x32x16_bf16 v[112:127], a[188:191], v[156:159], v[112:127]
    s_add_u32 s70, s70, 4096
    buffer_load_dwordx4 v[152:155], v22, s[4:7], s70 offen offset:0 sc1
    s_waitcnt vmcnt(11)
    v_mfma_f32_32x32x16_bf16 v[64:79], a[192:195], v[160:163], v[64:79]
    v_mfma_f32_32x32x16_bf16 v[80:95], a[196:199], v[160:163], v[80:95]
    s_add_u32 s71, s71, 4096
    buffer_load_dwordx4 v[156:159], v22, s[4:7], s71 offen offset:0 sc1
    v_mfma_f32_32x32x16_bf16 v[96:111], a[192:195], v[164:167], v[96:111]
    v_mfma_f32_32x32x16_bf16 v[112:127], a[196:199], v[164:167], v[112:127]
    buffer_load_dwordx4 v[160:163], v22, s[4:7], s70 offen offset:1024 sc1
    s_waitcnt vmcnt(7)
    v_mfma_f32_32x32x16_bf16 v[64:79], a[200:203], v[128:131], v[64:79]
    v_mfma_f32_32x32x16_bf16 v[80:95], a[204:207], v[128:131], v[80:95]
    buffer_load_dwordx4 v[164:167], v22, s[4:7], s71 offen offset:1024 sc1
    v_mfma_f32_32x32x16_bf16 v[96:111], a[200:203], v[132:135], v[96:111]
    v_mfma_f32_32x32x16_bf16 v[112:127], a[204:207], v[132:135], v[112:127]
    buffer_load_dwordx4 v[128:131], v22, s[4:7], s70 offen offset:2048 sc1
    s_waitcnt vmcnt(7)
    v_mfma_f32_32x32x16_bf16 v[64:79], a[208:211], v[136:139], v[64:79]
    v_mfma_f32_32x32x16_bf16 v[80:95], a[212:215], v[136:139], v[80:95]
    buffer_load_dwordx4 v[132:135], v22, s[4:7], s71 offen offset:2048 sc1
    v_mfma_f32_32x32x16_bf16 v[96:111], a[208:211], v[140:143], v[96:111]
    v_mfma_f32_32x32x16_bf16 v[112:127], a[212:215], v[140:143], v[112:127]
    buffer_load_dwordx4 v[136:139], v22, s[4:7], s70 offen offset:3072 sc1
    s_waitcnt vmcnt(7)
    v_mfma_f32_32x32x16_bf16 v[64:79], a[216:219], v[144:147], v[64:79]
    v_mfma_f32_32x32x16_bf16 v[80:95], a[220:223], v[144:147], v[80:95]
    buffer_load_dwordx4 v[140:143], v22, s[4:7], s71 offen offset:3072 sc1
    v_mfma_f32_32x32x16_bf16 v[96:111], a[216:219], v[148:151], v[96:111]
    v_mfma_f32_32x32x16_bf16 v[112:127], a[220:223], v[148:151], v[112:127]
    s_add_u32 s70, s70, 4096
    buffer_load_dwordx4 v[144:147], v22, s[4:7], s70 offen offset:0 sc1
    s_waitcnt vmcnt(7)
    v_mfma_f32_32x32x16_bf16 v[64:79], a[224:227], v[152:155], v[64:79]
    v_mfma_f32_32x32x16_bf16 v[80:95], a[228:231], v[152:155], v[80:95]
    s_add_u32 s71, s71, 4096
    buffer_load_dwordx4 v[148:151], v22, s[4:7], s71 offen offset:0 sc1
    v_mfma_f32_32x32x16_bf16 v[96:111], a[224:227], v[156:159], v[96:111]
    v_mfma_f32_32x32x16_bf16 v[112:127], a[228:231], v[156:159], v[112:127]
    buffer_load_dwordx4 v[152:155], v22, s[4:7], s70 offen offset:1024 sc1
    s_waitcnt vmcnt(7)
    v_mfma_f32_32x32x16_bf16 v[64:79], a[232:235], v[160:163], v[64:79]
    v_mfma_f32_32x32x16_bf16 v[80:95], a[236:239], v[160:163], v[80:95]
    buffer_load_dwordx4 v[156:159], v22, s[4:7], s71 offen offset:1024 sc1
    v_mfma_f32_32x32x16_bf16 v[96:111], a[232:235], v[164:167], v[96:111]
    v_mfma_f32_32x32x16_bf16 v[112:127], a[236:239], v[164:167], v[112:127]
    buffer_load_dwordx4 v[160:163], v22, s[4:7], s70 offen offset:2048 sc1
    s_waitcnt vmcnt(7)
    v_mfma_f32_32x32x16_bf16 v[64:79], a[240:243], v[128:131], v[64:79]
    v_mfma_f32_32x32x16_bf16 v[80:95], a[244:247], v[128:131], v[80:95]
    buffer_load_dwordx4 v[164:167], v22, s[4:7], s71 offen offset:2048 sc1
    v_mfma_f32_32x32x16_bf16 v[96:111], a[240:243], v[132:135], v[96:111]
    v_mfma_f32_32x32x16_bf16 v[112:127], a[244:247], v[132:135], v[112:127]
    buffer_load_dwordx4 v[128:131], v22, s[4:7], s70 offen offset:3072 sc1
    s_waitcnt vmcnt(7)
    v_mfma_f32_32x32x16_bf16 v[64:79], a[248:251], v[136:139], v[64:79]
    v_mfma_f32_32x32x16_bf16 v[80:95], a[252:255], v[136:139], v[80:95]
    buffer_load_dwordx4 v[132:135], v22, s[4:7], s71 offen offset:3072 sc1
    v_mfma_f32_32x32x16_bf16 v[96:111], a[248:251], v[140:143], v[96:111]
    v_mfma_f32_32x32x16_bf16 v[112:127], a[252:255], v[140:143], v[112:127]
    s_add_u32 s70, s70, 4096
    buffer_load_dwordx4 v[136:139], v22, s[4:7], s70 offen offset:0 sc1
    s_waitcnt vmcnt(7)
    v_mfma_f32_32x32x16_bf16 v[64:79], v[192:195], v[144:147], v[64:79]
    v_mfma_f32_32x32x16_bf16 v[80:95], v[196:199], v[144:147], v[80:95]
    s_add_u32 s71, s71, 4096
    buffer_load_dwordx4 v[140:143], v22, s[4:7], s71 offen offset:0 sc1
    v_mfma_f32_32x32x16_bf16 v[96:111], v[192:195], v[148:151], v[96:111]
    v_mfma_f32_32x32x16_bf16 v[112:127], v[196:199], v[148:151], v[112:127]
    buffer_load_dwordx4 v[144:147], v22, s[4:7], s70 offen offset:1024 sc1
    s_waitcnt vmcnt(7)
    v_mfma_f32_32x32x16_bf16 v[64:79], v[200:203], v[152:155], v[64:79]
    v_mfma_f32_32x32x16_bf16 v[80:95], v[204:207], v[152:155], v[80:95]
    buffer_load_dwordx4 v[148:151], v22, s[4:7], s71 offen offset:1024 sc1
    v_mfma_f32_32x32x16_bf16 v[96:111], v[200:203], v[156:159], v[96:111]
    v_mfma_f32_32x32x16_bf16 v[112:127], v[204:207], v[156:159], v[112:127]
    buffer_load_dwordx4 v[152:155], v22, s[4:7], s70 offen offset:2048 sc1
    s_waitcnt vmcnt(7)
    v_mfma_f32_32x32x16_bf16 v[64:79], v[208:211], v[160:163], v[64:79]
    v_mfma_f32_32x32x16_bf16 v[80:95], v[212:215], v[160:163], v[80:95]
    buffer_load_dwordx4 v[156:159], v22, s[4:7], s71 offen offset:2048 sc1
    v_mfma_f32_32x32x16_bf16 v[96:111], v[208:211], v[164:167], v[96:111]
    v_mfma_f32_32x32x16_bf16 v[112:127], v[212:215], v[164:167], v[112:127]
    buffer_load_dwordx4 v[160:163], v22, s[4:7], s70 offen offset:3072 sc1
    s_waitcnt vmcnt(7)
    v_mfma_f32_32x32x16_bf16 v[64:79], v[216:219], v[128:131], v[64:79]
    v_mfma_f32_32x32x16_bf16 v[80:95], v[220:223], v[128:131], v[80:95]
    buffer_load_dwordx4 v[164:167], v22, s[4:7], s71 offen offset:3072 sc1
    v_mfma_f32_32x32x16_bf16 v[96:111], v[216:219], v[132:135], v[96:111]
    v_mfma_f32_32x32x16_bf16 v[112:127], v[220:223], v[132:135], v[112:127]
    s_waitcnt vmcnt(6)
    v_mfma_f32_32x32x16_bf16 v[64:79], v[224:227], v[136:139], v[64:79]
    v_mfma_f32_32x32x16_bf16 v[80:95], v[228:231], v[136:139], v[80:95]
    v_mfma_f32_32x32x16_bf16 v[96:111], v[224:227], v[140:143], v[96:111]
    v_mfma_f32_32x32x16_bf16 v[112:127], v[228:231], v[140:143], v[112:127]
    s_waitcnt vmcnt(4)
    v_mfma_f32_32x32x16_bf16 v[64:79], v[232:235], v[144:147], v[64:79]
    v_mfma_f32_32x32x16_bf16 v[80:95], v[236:239], v[144:147], v[80:95]
    v_mfma_f32_32x32x16_bf16 v[96:111], v[232:235], v[148:151], v[96:111]
    v_mfma_f32_32x32x16_bf16 v[112:127], v[236:239], v[148:151], v[112:127]
    s_waitcnt vmcnt(2)
    v_mfma_f32_32x32x16_bf16 v[64:79], v[240:243], v[152:155], v[64:79]
    v_mfma_f32_32x32x16_bf16 v[80:95], v[244:247], v[152:155], v[80:95]
    v_mfma_f32_32x32x16_bf16 v[96:111], v[240:243], v[156:159], v[96:111]
    v_mfma_f32_32x32x16_bf16 v[112:127], v[244:247], v[156:159], v[112:127]
    s_waitcnt vmcnt(0)
    v_mfma_f32_32x32x16_bf16 v[64:79], v[248:251], v[160:163], v[64:79]
    v_mfma_f32_32x32x16_bf16 v[80:95], v[252:255], v[160:163], v[80:95]
    v_mfma_f32_32x32x16_bf16 v[96:111], v[248:251], v[164:167], v[96:111]
    v_mfma_f32_32x32x16_bf16 v[112:127], v[252:255], v[164:167], v[112:127]
    s_mov_b32 s49, 1
    s_branch L_epi
L_final:
    ds_write_b64 v180, v[2:3] offset:0
    ds_write_b64 v180, v[4:5] offset:32
    ds_write_b64 v180, v[6:7] offset:64
    ds_write_b64 v180, v[8:9] offset:96
    ds_write_b64 v180, v[10:11] offset:128
    s_waitcnt lgkmcnt(0)
    ds_read_b128 v[64:67], v181 offset:0
    ds_read_b128 v[68:71], v181 offset:1024
    ds_read_b128 v[72:75], v181 offset:2048
    s_waitcnt lgkmcnt(2)
    buffer_store_dwordx4 v[64:67], v182, s[8:11], s73 offen
    s_waitcnt lgkmcnt(1)
    buffer_store_dwordx4 v[68:71], v183, s[8:11], s73 offen
    s_waitcnt lgkmcnt(0)
    s_mov_b32 exec_hi, 0
    buffer_store_dwordx4 v[72:75], v184, s[8:11], s73 offen
    s_mov_b32 exec_hi, -1
L_end:
    s_endpgm
Lsig_2_slow:
    buffer_wbl2 sc1
    s_waitcnt vmcnt(0)
    buffer_store_dword v36, v22, s[4:7], s67 offen sc1
    s_branch Lsig_2_done
Lwl_5_retry:
    s_sub_u32 s66, s66, 1
    s_cmp_lg_u32 s66, 0
    s_cbranch_scc1 Lwl_5
    s_branch Lwl_5_ok
Lwl_5_inv:
    buffer_inv sc1
    s_waitcnt vmcnt(0)
    s_branch Lwl_5_fin
Lsig_25_slow:
    buffer_wbl2 sc1
    s_waitcnt vmcnt(0)
    buffer_store_dword v44, v22, s[4:7], s67 offen sc1
    s_branch Lsig_25_done
Lwl_26_retry:
    s_sub_u32 s66, s66, 1
    s_cmp_lg_u32 s66, 0
    s_cbranch_scc1 Lwl_26
    s_branch Lwl_26_ok
Lwl_26_inv:
    buffer_inv sc1
    s_waitcnt vmcnt(0)
    s_branch Lwl_26_fin
Ly_27_spin0:
    s_mov_b32 s66, 0x40000
Ly_27_spin:
    buffer_load_dword v50, v0, s[4:7], s71 offen sc1
    s_waitcnt vmcnt(0)
    v_cmp_eq_u32 vcc, 1, v50
    s_nop 0
    s_cmp_eq_u32 vcc_lo, -1
    s_cbranch_scc1 Ly_27_ok
    s_sub_u32 s66, s66, 1
    s_cmp_lg_u32 s66, 0
    s_cbranch_scc1 Ly_27_spin
    s_branch Ly_27_ok
Lxs_28_retry:
    s_sub_u32 s66, s66, 1
    s_cmp_lg_u32 s66, 0
    s_cbranch_scc1 Lxs_28_poll
    s_branch Lxs_28_have
Lxs_28_slow:
    v_mov_b32 v44, s95
    s_cmp_eq_u32 s46, 0
    s_waitcnt vmcnt(0)
    s_barrier
    s_cbranch_scc0 Lsg_32
    s_mov_b64 exec, 1
    s_cmp_eq_u32 s50, 1
    s_cbranch_scc0 Lsig_33_slow
    buffer_store_dword v44, v22, s[4:7], s67 offen
Lsig_33_done:
    s_mov_b64 exec, -1
Lsg_32:
    s_mov_b32 s66, 0x40000
Lwl_34:
    buffer_load_dword v44, v0, s[4:7], s64 offen sc1
    s_waitcnt vmcnt(0)
    v_cmp_le_u32 vcc, s95, v44
    s_nop 0
    s_and_b32 s52, vcc_lo, s97
    s_cmp_eq_u32 s52, s97
    s_cbranch_scc0 Lwl_34_retry
Lwl_34_ok:
    s_cmp_eq_u32 s50, 1
    s_cbranch_scc0 Lwl_34_inv
Lwl_34_fin:
    buffer_load_dwordx4 v[48:51], v56, s[4:7], s72 offen sc1
    s_waitcnt vmcnt(0)
    s_branch Lxs_28_have
Lsig_30_slow:
    buffer_wbl2 sc1
    s_waitcnt vmcnt(0)
    buffer_store_dword v44, v22, s[4:7], s67 offen sc1
    s_branch Lsig_30_done
Lwl_31_retry:
    s_sub_u32 s66, s66, 1
    s_cmp_lg_u32 s66, 0
    s_cbranch_scc1 Lwl_31
    s_branch Lwl_31_ok
Lwl_31_inv:
    buffer_inv sc1
    s_waitcnt vmcnt(0)
    s_branch Lwl_31_fin
Lsig_33_slow:
    buffer_wbl2 sc1
    s_waitcnt vmcnt(0)
    buffer_store_dword v44, v22, s[4:7], s67 offen sc1
    s_branch Lsig_33_done
Lwl_34_retry:
    s_sub_u32 s66, s66, 1
    s_cmp_lg_u32 s66, 0
    s_cbranch_scc1 Lwl_34
    s_branch Lwl_34_ok
Lwl_34_inv:
    buffer_inv sc1
    s_waitcnt vmcnt(0)
    s_branch Lwl_34_fin
Lfin_22_fb:
    v_mov_b32 v104, v32
    v_mov_b32 v105, v33
    v_mov_b32 v106, v34
    v_mov_b32 v107, v35
    v_mov_b32 v108, v36
    v_mov_b32 v109, v37
    v_mov_b32 v110, v38
    v_mov_b32 v111, v39
    s_mov_b32 s89, s88
    s_getpc_b64 s[90:91]
Lfbret_35_pc:
    s_add_u32 s90, s90, Lfbret_35-Lfbret_35_pc
    s_addc_u32 s91, s91, 0
    s_branch L_fallback
Lfbret_35:
    v_mov_b32 v80, v112
    v_mov_b32 v81, v113
    v_mov_b32 v82, v114
    v_mov_b32 v83, v115
    v_mov_b32 v84, v116
    v_mov_b32 v85, v117
    v_mov_b32 v86, v118
    v_mov_b32 v87, v119
    v_mov_b32 v88, v120
    v_mov_b32 v89, v121
    v_mov_b32 v90, v122
    v_mov_b32 v91, v123
    v_mov_b32 v92, v124
    v_mov_b32 v93, v125
    v_mov_b32 v94, v126
    v_mov_b32 v95, v127
    v_mov_b32 v46, v88
    v_mov_b32 v47, v88
    s_nop 1
    v_permlane32_swap_b32 v46, v47
    v_rcp_f32 v48, v47
    s_branch Lfin_22_ok
Lfin_23_fb:
    v_mov_b32 v104, v24
    v_mov_b32 v105, v25
    v_mov_b32 v106, v26
    v_mov_b32 v107, v27
    v_mov_b32 v108, v28
    v_mov_b32 v109, v29
    v_mov_b32 v110, v30
    v_mov_b32 v111, v31
    s_mov_b32 s89, s87
    s_getpc_b64 s[90:91]
Lfbret_36_pc:
    s_add_u32 s90, s90, Lfbret_36-Lfbret_36_pc
    s_addc_u32 s91, s91, 0
    s_branch L_fallback
Lfbret_36:
    v_mov_b32 v64, v112
    v_mov_b32 v65, v113
    v_mov_b32 v66, v114
    v_mov_b32 v67, v115
    v_mov_b32 v68, v116
    v_mov_b32 v69, v117
    v_mov_b32 v70, v118
    v_mov_b32 v71, v119
    v_mov_b32 v72, v120
    v_mov_b32 v73, v121
    v_mov_b32 v74, v122
    v_mov_b32 v75, v123
    v_mov_b32 v76, v124
    v_mov_b32 v77, v125
    v_mov_b32 v78, v126
    v_mov_b32 v79, v127
    v_mov_b32 v46, v72
    v_mov_b32 v47, v72
    s_nop 1
    v_permlane32_swap_b32 v46, v47
    v_rcp_f32 v48, v47
    s_branch Lfin_23_ok
L_fallback:
    v_and_b32 v46, 31, v1
    v_mul_u32_u24 v46, 48, v46
    v_lshrrev_b32 v47, 5, v1
    v_lshl_add_u32 v44, v47, 4, v46
    v_bfe_u32 v46, v1, 2, 2
    v_lshl_add_u32 v46, v47, 2, v46
    v_mul_u32_u24 v46, 48, v46
    v_bfe_u32 v47, v1, 4, 1
    v_lshl_add_u32 v46, v47, 5, v46
    v_and_b32 v47, 3, v1
    v_lshl_add_u32 v46, v47, 3, v46
    v_add_u32 v45, 12288, v46
    v_and_b32 v43, 31, v1
    v_mul_u32_u24 v43, 48, v43
    v_add_u32 v43, 32, v43
    s_add_u32 s93, s89, 1
    s_cmp_eq_u32 s44, 0
    s_cselect_b32 s93, s93, 9
    v_mov_b32 v128, 0xf149f2ca
    s_mov_b32 s92, 0
L_fb_p1:
    s_sub_i32 s52, s89, s92
    s_cmp_lt_i32 s52, 0
    s_cselect_b32 s53, 36864, 0
    s_mul_i32 s52, s52, 1536
    s_add_u32 s52, s52, s53
    v_add_u32 v40, s52, v44
    v_add_u32 v41, s52, v43
    v_add_u32 v42, s52, v45
    v_and_b32 v46, 31, v1
    v_lshrrev_b32 v47, 5, v1
    v_lshlrev_b32 v47, 2, v47
    v_sub_u32 v46, v46, v47
    v_mov_b32 v47, 0xf149f2ca
    v_mov_b32 v48, 0
    s_cmp_eq_u32 s92, 0
    s_cbranch_scc1 L_fb_b1_own
    s_cmp_eq_u32 s92, 8
    s_cbranch_scc1 L_fb_b1_halo
    v_mov_b32 v160, v48
    v_mov_b32 v161, v48
    v_mov_b32 v162, v48
    v_mov_b32 v163, v48
    v_mov_b32 v164, v48
    v_mov_b32 v165, v48
    v_mov_b32 v166, v48
    v_mov_b32 v167, v48
    v_mov_b32 v168, v48
    v_mov_b32 v169, v48
    v_mov_b32 v170, v48
    v_mov_b32 v171, v48
    v_mov_b32 v172, v48
    v_mov_b32 v173, v48
    v_mov_b32 v174, v48
    v_mov_b32 v175, v48
    s_branch L_fb_b1_done
L_fb_b1_own:
    v_cmp_le_i32 vcc, 0, v46
    s_nop 1
    v_cndmask_b32 v160, v47, v48, vcc
    v_cmp_le_i32 vcc, 1, v46
    s_nop 1
    v_cndmask_b32 v161, v47, v48, vcc
    v_cmp_le_i32 vcc, 2, v46
    s_nop 1
    v_cndmask_b32 v162, v47, v48, vcc
    v_cmp_le_i32 vcc, 3, v46
    s_nop 1
    v_cndmask_b32 v163, v47, v48, vcc
    v_cmp_le_i32 vcc, 8, v46
    s_nop 1
    v_cndmask_b32 v164, v47, v48, vcc
    v_cmp_le_i32 vcc, 9, v46
    s_nop 1
    v_cndmask_b32 v165, v47, v48, vcc
    v_cmp_le_i32 vcc, 10, v46
    s_nop 1
    v_cndmask_b32 v166, v47, v48, vcc
    v_cmp_le_i32 vcc, 11, v46
    s_nop 1
    v_cndmask_b32 v167, v47, v48, vcc
    v_cmp_le_i32 vcc, 16, v46
    s_nop 1
    v_cndmask_b32 v168, v47, v48, vcc
    v_cmp_le_i32 vcc, 17, v46
    s_nop 1
    v_cndmask_b32 v169, v47, v48, vcc
    v_cmp_le_i32 vcc, 18, v46
    s_nop 1
    v_cndmask_b32 v170, v47, v48, vcc
    v_cmp_le_i32 vcc, 19, v46
    s_nop 1
    v_cndmask_b32 v171, v47, v48, vcc
    v_cmp_le_i32 vcc, 24, v46
    s_nop 1
    v_cndmask_b32 v172, v47, v48, vcc
    v_cmp_le_i32 vcc, 25, v46
    s_nop 1
    v_cndmask_b32 v173, v47, v48, vcc
    v_cmp_le_i32 vcc, 26, v46
    s_nop 1
    v_cndmask_b32 v174, v47, v48, vcc
    v_cmp_le_i32 vcc, 27, v46
    s_nop 1
    v_cndmask_b32 v175, v47, v48, vcc
    s_branch L_fb_b1_done
L_fb_b1_halo:
    v_cmp_le_i32 vcc, 0, v46
    s_nop 1
    v_cndmask_b32 v160, v48, v47, vcc
    v_cmp_le_i32 vcc, 1, v46
    s_nop 1
    v_cndmask_b32 v161, v48, v47, vcc
    v_cmp_le_i32 vcc, 2, v46
    s_nop 1
    v_cndmask_b32 v162, v48, v47, vcc
    v_cmp_le_i32 vcc, 3, v46
    s_nop 1
    v_cndmask_b32 v163, v48, v47, vcc
    v_cmp_le_i32 vcc, 8, v46
    s_nop 1
    v_cndmask_b32 v164, v48, v47, vcc
    v_cmp_le_i32 vcc, 9, v46
    s_nop 1
    v_cndmask_b32 v165, v48, v47, vcc
    v_cmp_le_i32 vcc, 10, v46
    s_nop 1
    v_cndmask_b32 v166, v48, v47, vcc
    v_cmp_le_i32 vcc, 11, v46
    s_nop 1
    v_cndmask_b32 v167, v48, v47, vcc
    v_cmp_le_i32 vcc, 16, v46
    s_nop 1
    v_cndmask_b32 v168, v48, v47, vcc
    v_cmp_le_i32 vcc, 17, v46
    s_nop 1
    v_cndmask_b32 v169, v48, v47, vcc
    v_cmp_le_i32 vcc, 18, v46
    s_nop 1
    v_cndmask_b32 v170, v48, v47, vcc
    v_cmp_le_i32 vcc, 19, v46
    s_nop 1
    v_cndmask_b32 v171, v48, v47, vcc
    v_cmp_le_i32 vcc, 24, v46
    s_nop 1
    v_cndmask_b32 v172, v48, v47, vcc
    v_cmp_le_i32 vcc, 25, v46
    s_nop 1
    v_cndmask_b32 v173, v48, v47, vcc
    v_cmp_le_i32 vcc, 26, v46
    s_nop 1
    v_cndmask_b32 v174, v48, v47, vcc
    v_cmp_le_i32 vcc, 27, v46
    s_nop 1
    v_cndmask_b32 v175, v48, v47, vcc
L_fb_b1_done:
    ds_read_b128 v[136:139], v40
    ds_read_b128 v[140:143], v41
    s_waitcnt lgkmcnt(0)
    v_mfma_f32_32x32x16_bf16 v[144:159], v[136:139], v[104:107], v[160:175]
    v_mfma_f32_32x32x16_bf16 v[144:159], v[140:143], v[108:111], v[144:159]
    s_nop 11
    v_max3_f32 v128, v128, v144, v145
    v_max3_f32 v128, v128, v146, v147
    v_max3_f32 v128, v128, v148, v149
    v_max3_f32 v128, v128, v150, v151
    v_max3_f32 v128, v128, v152, v153
    v_max3_f32 v128, v128, v154, v155
    v_max3_f32 v128, v128, v156, v157
    v_max3_f32 v128, v128, v158, v159
    s_add_u32 s92, s92, 1
    s_cmp_lt_u32 s92, s93
    s_cbranch_scc1 L_fb_p1
    v_mov_b32 v46, v128
    s_nop 1
    v_permlane32_swap_b32 v46, v128
    v_max_f32 v128, v128, v46
    v_mov_b32 v112, 0
    v_mov_b32 v113, 0
    v_mov_b32 v114, 0
    v_mov_b32 v115, 0
    v_mov_b32 v116, 0
    v_mov_b32 v117, 0
    v_mov_b32 v118, 0
    v_mov_b32 v119, 0
    v_mov_b32 v120, 0
    v_mov_b32 v121, 0
    v_mov_b32 v122, 0
    v_mov_b32 v123, 0
    v_mov_b32 v124, 0
    v_mov_b32 v125, 0
    v_mov_b32 v126, 0
    v_mov_b32 v127, 0
    s_mov_b32 s92, 0
L_fb_p2:
    s_sub_i32 s52, s89, s92
    s_cmp_lt_i32 s52, 0
    s_cselect_b32 s53, 36864, 0
    s_mul_i32 s52, s52, 1536
    s_add_u32 s52, s52, s53
    v_add_u32 v40, s52, v44
    v_add_u32 v41, s52, v43
    v_add_u32 v42, s52, v45
    v_and_b32 v46, 31, v1
    v_lshrrev_b32 v47, 5, v1
    v_lshlrev_b32 v47, 2, v47
    v_sub_u32 v46, v46, v47
    v_mov_b32 v47, 0xf149f2ca
    v_sub_f32 v48, 0, v128
    s_cmp_eq_u32 s92, 0
    s_cbranch_scc1 L_fb_b2_own
    s_cmp_eq_u32 s92, 8
    s_cbranch_scc1 L_fb_b2_halo
    v_mov_b32 v160, v48
    v_mov_b32 v161, v48
    v_mov_b32 v162, v48
    v_mov_b32 v163, v48
    v_mov_b32 v164, v48
    v_mov_b32 v165, v48
    v_mov_b32 v166, v48
    v_mov_b32 v167, v48
    v_mov_b32 v168, v48
    v_mov_b32 v169, v48
    v_mov_b32 v170, v48
    v_mov_b32 v171, v48
    v_mov_b32 v172, v48
    v_mov_b32 v173, v48
    v_mov_b32 v174, v48
    v_mov_b32 v175, v48
    s_branch L_fb_b2_done
L_fb_b2_own:
    v_cmp_le_i32 vcc, 0, v46
    s_nop 1
    v_cndmask_b32 v160, v47, v48, vcc
    v_cmp_le_i32 vcc, 1, v46
    s_nop 1
    v_cndmask_b32 v161, v47, v48, vcc
    v_cmp_le_i32 vcc, 2, v46
    s_nop 1
    v_cndmask_b32 v162, v47, v48, vcc
    v_cmp_le_i32 vcc, 3, v46
    s_nop 1
    v_cndmask_b32 v163, v47, v48, vcc
    v_cmp_le_i32 vcc, 8, v46
    s_nop 1
    v_cndmask_b32 v164, v47, v48, vcc
    v_cmp_le_i32 vcc, 9, v46
    s_nop 1
    v_cndmask_b32 v165, v47, v48, vcc
    v_cmp_le_i32 vcc, 10, v46
    s_nop 1
    v_cndmask_b32 v166, v47, v48, vcc
    v_cmp_le_i32 vcc, 11, v46
    s_nop 1
    v_cndmask_b32 v167, v47, v48, vcc
    v_cmp_le_i32 vcc, 16, v46
    s_nop 1
    v_cndmask_b32 v168, v47, v48, vcc
    v_cmp_le_i32 vcc, 17, v46
    s_nop 1
    v_cndmask_b32 v169, v47, v48, vcc
    v_cmp_le_i32 vcc, 18, v46
    s_nop 1
    v_cndmask_b32 v170, v47, v48, vcc
    v_cmp_le_i32 vcc, 19, v46
    s_nop 1
    v_cndmask_b32 v171, v47, v48, vcc
    v_cmp_le_i32 vcc, 24, v46
    s_nop 1
    v_cndmask_b32 v172, v47, v48, vcc
    v_cmp_le_i32 vcc, 25, v46
    s_nop 1
    v_cndmask_b32 v173, v47, v48, vcc
    v_cmp_le_i32 vcc, 26, v46
    s_nop 1
    v_cndmask_b32 v174, v47, v48, vcc
    v_cmp_le_i32 vcc, 27, v46
    s_nop 1
    v_cndmask_b32 v175, v47, v48, vcc
    s_branch L_fb_b2_done
L_fb_b2_halo:
    v_cmp_le_i32 vcc, 0, v46
    s_nop 1
    v_cndmask_b32 v160, v48, v47, vcc
    v_cmp_le_i32 vcc, 1, v46
    s_nop 1
    v_cndmask_b32 v161, v48, v47, vcc
    v_cmp_le_i32 vcc, 2, v46
    s_nop 1
    v_cndmask_b32 v162, v48, v47, vcc
    v_cmp_le_i32 vcc, 3, v46
    s_nop 1
    v_cndmask_b32 v163, v48, v47, vcc
    v_cmp_le_i32 vcc, 8, v46
    s_nop 1
    v_cndmask_b32 v164, v48, v47, vcc
    v_cmp_le_i32 vcc, 9, v46
    s_nop 1
    v_cndmask_b32 v165, v48, v47, vcc
    v_cmp_le_i32 vcc, 10, v46
    s_nop 1
    v_cndmask_b32 v166, v48, v47, vcc
    v_cmp_le_i32 vcc, 11, v46
    s_nop 1
    v_cndmask_b32 v167, v48, v47, vcc
    v_cmp_le_i32 vcc, 16, v46
    s_nop 1
    v_cndmask_b32 v168, v48, v47, vcc
    v_cmp_le_i32 vcc, 17, v46
    s_nop 1
    v_cndmask_b32 v169, v48, v47, vcc
    v_cmp_le_i32 vcc, 18, v46
    s_nop 1
    v_cndmask_b32 v170, v48, v47, vcc
    v_cmp_le_i32 vcc, 19, v46
    s_nop 1
    v_cndmask_b32 v171, v48, v47, vcc
    v_cmp_le_i32 vcc, 24, v46
    s_nop 1
    v_cndmask_b32 v172, v48, v47, vcc
    v_cmp_le_i32 vcc, 25, v46
    s_nop 1
    v_cndmask_b32 v173, v48, v47, vcc
    v_cmp_le_i32 vcc, 26, v46
    s_nop 1
    v_cndmask_b32 v174, v48, v47, vcc
    v_cmp_le_i32 vcc, 27, v46
    s_nop 1
    v_cndmask_b32 v175, v48, v47, vcc
L_fb_b2_done:
    ds_read_b128 v[136:139], v40
    ds_read_b128 v[140:143], v41
    ds_read_b64_tr_b16 v[96:97], v42 offset:0
    ds_read_b64_tr_b16 v[98:99], v42 offset:384
    ds_read_b64_tr_b16 v[100:101], v42 offset:768
    ds_read_b64_tr_b16 v[102:103], v42 offset:1152
    s_waitcnt lgkmcnt(0)
    v_mfma_f32_32x32x16_bf16 v[144:159], v[136:139], v[104:107], v[160:175]
    v_mfma_f32_32x32x16_bf16 v[144:159], v[140:143], v[108:111], v[144:159]
    s_nop 11
    v_exp_f32 v144, v144
    v_exp_f32 v145, v145
    v_exp_f32 v146, v146
    v_exp_f32 v147, v147
    v_exp_f32 v148, v148
    v_exp_f32 v149, v149
    v_exp_f32 v150, v150
    v_exp_f32 v151, v151
    v_exp_f32 v152, v152
    v_exp_f32 v153, v153
    v_exp_f32 v154, v154
    v_exp_f32 v155, v155
    v_exp_f32 v156, v156
    v_exp_f32 v157, v157
    v_exp_f32 v158, v158
    v_exp_f32 v159, v159
    v_cvt_pk_bf16_f32 v132, v144, v145
    v_cvt_pk_bf16_f32 v133, v146, v147
    v_cvt_pk_bf16_f32 v134, v148, v149
    v_cvt_pk_bf16_f32 v135, v150, v151
    v_cvt_pk_bf16_f32 v136, v152, v153
    v_cvt_pk_bf16_f32 v137, v154, v155
    v_cvt_pk_bf16_f32 v138, v156, v157
    v_cvt_pk_bf16_f32 v139, v158, v159
    v_mfma_f32_32x32x16_bf16 v[112:127], v[96:99], v[132:135], v[112:127]
    s_nop 0
    v_mfma_f32_32x32x16_bf16 v[112:127], v[100:103], v[136:139], v[112:127]
    s_add_u32 s92, s92, 1
    s_cmp_lt_u32 s92, s93
    s_cbranch_scc1 L_fb_p2
    s_nop 15
    s_setpc_b64 s[90:91]
L_code_end:
.section .rodata,"a"
.p2align 6
.amdhsa_kernel interleave_layers__sliding_block__ssm_conv_h3__prompt_kernel
  .amdhsa_next_free_vgpr 512
  .amdhsa_next_free_sgpr 102
  .amdhsa_accum_offset 256
  .amdhsa_group_segment_fixed_size 0
  .amdhsa_kernarg_size 96
  .amdhsa_user_sgpr_count 2
  .amdhsa_user_sgpr_kernarg_segment_ptr 1
  .amdhsa_system_sgpr_workgroup_id_x 1
.end_amdhsa_kernel
```
